```python
import torch

def _softmax(x, axis=-1):
    return torch.softmax(x, dim=axis)
def _gelu(x):
    return torch.nn.functional.gelu(x, approximate="tanh")
def _silu(x):
    return torch.nn.functional.silu(x)
def _sigmoid(x):
    return torch.sigmoid(x)
def _layernorm(x, axis=-1, eps=1e-5):
    m = x.mean(dim=axis, keepdim=True)
    v = x.var(dim=axis, keepdim=True, unbiased=False)
    return (x - m) / torch.sqrt(v + eps)
def _scatter_add(tgt, idx, src, axis=0):
    return tgt.clone().index_add_(axis, idx, src)
def _segment_sum(src, seg, n):
    out = torch.zeros((n,) + src.shape[1:], dtype=src.dtype)
    return out.index_add_(0, seg, src)
def _pad(x, pw):
    flat = tuple(v for pair in reversed(pw) for v in pair)
    return torch.nn.functional.pad(x, flat)

kernel_name = 'gated_mix__ssm_conv_h3__dense_activation_gelu__prompt'

def setup_inputs():

    _w = (lambda a: (lambda t: t.to(torch.bfloat16) if t.is_floating_point() else t)(torch.as_tensor(a)))
    def _A_setup():
        B, S, D = 1, 2048, 576
        ks = 4
        return {
            "q": _w((lambda *s: torch.randn(*s, dtype=torch.bfloat16) * 0.05)(B, S, D)),
            "k": _w((lambda *s: torch.randn(*s, dtype=torch.bfloat16) * 0.4)(B, S, D)),
            "v": _w((lambda *s: torch.randn(*s, dtype=torch.bfloat16) * 0.2)(B, S, D)),
            "shift_k": _w((lambda *s: torch.randn(*s, dtype=torch.bfloat16) * 0.4)(D, ks) * 0.5),
            "ssm_k": _w((lambda *s: torch.randn(*s, dtype=torch.bfloat16) * 0.4)(D, S) * (1.0 / S ** 0.5)),
            "ssm_D": _w((lambda *s: torch.randn(*s, dtype=torch.bfloat16) * 0.2)(D)),
        }
    _A_in = _A_setup()

    def _B_setup():
        B, S, D, F = 1, 2048, 576, 4608
        return {
            "x": _w((lambda *s: torch.randn(*s, dtype=torch.bfloat16) * 0.05)(B, S, D)),
            "w1": _w((lambda *s: torch.randn(*s, dtype=torch.bfloat16) * 3.2)(D, F) * (D ** -0.5)),
            "b1": _w((lambda *s: torch.randn(*s, dtype=torch.bfloat16) * 3.2)(F) * 0.01),
            "w2": _w((lambda *s: torch.randn(*s, dtype=torch.bfloat16) * 0.05)(F, D) * (F ** -0.5)),
            "b2": _w((lambda *s: torch.randn(*s, dtype=torch.bfloat16) * 0.1)(D) * 0.01),
        }
    _B_in = _B_setup()

    return {
        "A_q": _A_in["q"],
        "A_k": _A_in["k"],
        "A_v": _A_in["v"],
        "A_shift_k": _A_in["shift_k"],
        "A_ssm_k": _A_in["ssm_k"],
        "A_ssm_D": _A_in["ssm_D"],
        "B_x": _B_in["x"],
        "B_w1": _B_in["w1"],
        "B_b1": _B_in["b1"],
        "B_w2": _B_in["w2"],
        "B_b2": _B_in["b2"],
        "gate_w": _w((lambda *s: torch.randn(*s, dtype=torch.bfloat16) * 0.05)(576) * 16.0),
    }

def reference(A_q, A_k, A_v, A_shift_k, A_ssm_k, A_ssm_D, B_x, B_w1, B_b1, B_w2, B_b2, gate_w):
    def _A_ref(q, k, v, shift_k, ssm_k, ssm_D):
        B, S, D = q.shape
        ks = shift_k.shape[-1]
        k_pad = _pad(k, ((0, 0), (ks - 1, 0), (0, 0)))
        k_shift = torch.zeros_like(k)
        for t in range(ks):
            k_shift = k_shift + k_pad[:, t:t + S, :] * shift_k[:, ks - 1 - t][None, None, :]
        kv = k_shift * v
        L = 2 * S
        kv_pad = _pad(kv, ((0, 0), (0, S), (0, 0)))
        kf_pad = _pad(ssm_k, ((0, 0), (0, S)))
        kv_f = (lambda x, axes=(-2,-1): torch.fft.rfft2(x.float(), dim=axes))(kv_pad[:, None, :, :], axes=(1, 2))
        kf_f = (lambda x, axes=(-2,-1): torch.fft.rfft2(x.float(), dim=axes))(kf_pad[:, None, :], axes=(1, 2))
        kf_f = (lambda x, *d: x.permute(*d))(kf_f, 1, 2, 0)
        y_f = kv_f * kf_f[None, :, :, :]
        y = (lambda x, s, axes=(-2,-1): torch.fft.irfft2(x, s=s, dim=axes).to(torch.bfloat16))(y_f, (1, L), axes=(1, 2))[:, 0, :S, :]
        y = y + kv * ssm_D[None, None, :]
        return q * y

    def _B_ref(x, w1, b1, w2, b2):
        h = torch.einsum("bsd,df->bsf", x, w1) + b1
        h = _gelu(h)
        return torch.einsum("bsf,fd->bsd", h, w2) + b2

    x = A_q
    g = _sigmoid((x * gate_w).sum(-1, keepdims=True))
    a = _A_ref(x, A_k, A_v, A_shift_k, A_ssm_k, A_ssm_D)
    b = _B_ref(x, B_w1, B_b1, B_w2, B_b2)
    return g * a + (1 - g) * b
```

```asm
; @launch grid=(256,1,1) block=(512,1,1) lds=163840
.amdgcn_target "amdgcn-amd-amdhsa--gfx950"
.text
.globl gated_mix__ssm_conv_h3__dense_activation_gelu__prompt_kernel
.p2align 8
.type gated_mix__ssm_conv_h3__dense_activation_gelu__prompt_kernel,@function
gated_mix__ssm_conv_h3__dense_activation_gelu__prompt_kernel:
    s_cmp_ge_u32 s2, 256
    s_cbranch_scc1 gated_mix__ssm_conv_h3__dense_activation_gelu__prompt_kernel_end
    s_load_dwordx4 s[48:51], s[0:1], 0
    s_load_dwordx4 s[52:55], s[0:1], 16
    s_load_dwordx2 s[38:39], s[0:1], 56
    s_load_dwordx2 s[40:41], s[0:1], 64
    s_load_dwordx2 s[42:43], s[0:1], 112
    s_load_dwordx2 s[56:57], s[0:1], 88
    s_load_dwordx2 s[58:59], s[0:1], 104
    v_and_b32 v1, 63, v0
    v_lshrrev_b32 v2, 6, v0
    s_and_b32 s33, s2, 7
    s_lshr_b32 s34, s2, 3
    s_and_b32 s24, s33, 3
    s_lshr_b32 s33, s33, 2
    s_lshl_b32 s33, s33, 3
    s_lshr_b32 s16, s34, 2
    s_add_u32 s16, s16, s33
    s_and_b32 s34, s34, 3
    s_lshl_b32 s17, s24, 2
    s_add_u32 s17, s17, s34
    s_mul_i32 s23, s24, 3
    s_add_u32 s23, s23, s34
    s_mul_i32 s31, s17, 9
    s_lshr_b32 s18, s31, 1
    v_readfirstlane_b32 s98, v2
    s_nop 3
    s_mov_b32 s3, s34
    s_and_b32 s20, s98, 3
    s_lshr_b32 s21, s98, 2
    v_lshrrev_b32 v16, 3, v1
    s_movk_i32 s33, 9216
    v_mul_lo_u32 v34, v16, s33
    v_and_b32 v17, 7, v1
    v_bfe_u32 v18, v1, 4, 1
    v_lshlrev_b32 v18, 2, v18
    v_xor_b32 v18, v17, v18
    v_lshl_add_u32 v34, v18, 4, v34
    v_lshrrev_b32 v19, 6, v0
    v_lshl_add_u32 v18, v19, 3, v16
    s_movk_i32 s33, 1152
    v_mul_lo_u32 v35, v18, s33
    v_and_b32 v20, 1, v19
    v_lshlrev_b32 v20, 2, v20
    v_lshrrev_b32 v21, 4, v1
    v_add_u32 v20, v20, v21
    v_xor_b32 v20, v17, v20
    v_lshl_add_u32 v35, v20, 4, v35
    v_lshlrev_b32 v36, 4, v1
    s_waitcnt lgkmcnt(0)

    v_mov_b32 v52, 0
    v_mov_b32 v53, 0
    s_mov_b32 s4, s48
    s_mov_b32 s5, s49
    s_mov_b32 s6, 2359296
    s_mov_b32 s7, 0x00020000
    s_lshl_b32 s33, s18, 7
    s_sub_u32 s10, 5308416, s33
    s_and_b32 s34, s17, 1
    s_lshl_b32 s34, s34, 7
    s_add_u32 s33, s33, s34
    s_add_u32 s8, s38, s33
    s_addc_u32 s9, s39, 0
    s_mov_b32 s11, 0x00020000

    s_mul_i32 s33, s98, 221184

    s_add_u32 s80, s33, 0
    s_add_u32 s81, s33, 73728
    s_add_u32 s82, s33, 147456
    s_add_u32 s83, s33, 1769472
    s_add_u32 s84, s33, 1843200
    s_add_u32 s85, s33, 1916928
    s_add_u32 s86, s33, 3538944
    s_add_u32 s87, s33, 3612672
    s_add_u32 s88, s33, 3686400
    s_mul_i32 s22, s98, 3072
    s_mul_i32 s91, s16, 147456
    s_lshl_b32 s30, s98, 10
    s_add_u32 m0, s30, 49152
    s_add_u32 s29, s91, 0
    buffer_load_dwordx4 v35, s[4:7], s29 offen lds
    s_lshl_b32 s30, s98, 10
    s_add_u32 m0, s30, 57344
    s_add_u32 s29, s91, 73728
    buffer_load_dwordx4 v35, s[4:7], s29 offen lds
    s_lshl_b32 s30, s98, 10
    s_add_u32 m0, s30, 65536
    s_add_u32 s29, s91, 128
    buffer_load_dwordx4 v35, s[4:7], s29 offen lds
    s_lshl_b32 s30, s98, 10
    s_add_u32 m0, s30, 73728
    s_add_u32 s29, s91, 73856
    buffer_load_dwordx4 v35, s[4:7], s29 offen lds
    s_lshl_b32 s30, s98, 10
    s_add_u32 m0, s30, 81920
    s_add_u32 s29, s91, 256
    buffer_load_dwordx4 v35, s[4:7], s29 offen lds
    s_lshl_b32 s30, s98, 10
    s_add_u32 m0, s30, 90112
    s_add_u32 s29, s91, 73984
    buffer_load_dwordx4 v35, s[4:7], s29 offen lds
    s_add_u32 m0, s22, 0
    s_nop 0
    buffer_load_dwordx4 v34, s[8:11], s80 offen lds
    s_add_u32 m0, s22, 1024
    s_nop 0
    buffer_load_dwordx4 v34, s[8:11], s81 offen lds
    s_add_u32 m0, s22, 2048
    s_nop 0
    buffer_load_dwordx4 v34, s[8:11], s82 offen lds
    s_mov_b32 s44, s40
    s_mov_b32 s45, s41
    s_mov_b32 s46, 9216
    s_mov_b32 s47, 0x00020000
    s_lshl_b32 s33, s18, 7
    v_lshlrev_b32 v33, 1, v0
    v_add_u32 v33, s33, v33
    v_min_u32 v33, 9214, v33
    buffer_load_ushort v39, v33, s[44:47], 0 offen

    s_barrier
    s_add_u32 m0, s22, 24576
    s_nop 0
    buffer_load_dwordx4 v34, s[8:11], s83 offen lds
    s_add_u32 m0, s22, 25600
    s_nop 0
    buffer_load_dwordx4 v34, s[8:11], s84 offen lds
    s_add_u32 m0, s22, 26624
    s_nop 0
    buffer_load_dwordx4 v34, s[8:11], s85 offen lds
    s_lshl_b32 s30, s98, 10
    s_add_u32 m0, s30, 98304
    s_add_u32 s29, s91, 384
    buffer_load_dwordx4 v35, s[4:7], s29 offen lds
    s_lshl_b32 s30, s98, 10
    s_add_u32 m0, s30, 106496
    s_add_u32 s29, s91, 74112
    buffer_load_dwordx4 v35, s[4:7], s29 offen lds
    s_lshl_b32 s30, s98, 10
    s_add_u32 m0, s30, 114688
    s_add_u32 s29, s91, 512
    buffer_load_dwordx4 v35, s[4:7], s29 offen lds
    s_lshl_b32 s30, s98, 10
    s_add_u32 m0, s30, 122880
    s_add_u32 s29, s91, 74240
    buffer_load_dwordx4 v35, s[4:7], s29 offen lds
    s_lshl_b32 s30, s98, 10
    s_add_u32 m0, s30, 131072
    s_add_u32 s29, s91, 640
    buffer_load_dwordx4 v35, s[4:7], s29 offen lds
    s_lshl_b32 s30, s98, 10
    s_add_u32 m0, s30, 139264
    s_add_u32 s29, s91, 74368
    buffer_load_dwordx4 v35, s[4:7], s29 offen lds
    s_cmp_lg_u32 s98, 7
    s_cbranch_scc1 gated_mix__ssm_conv_h3__dense_activation_gelu__prompt_kernel_nopt
    s_and_b32 s33, s17, 3
    s_lshl_b32 s33, s33, 5
    v_mul_u32_u24 v2, 21846, v1
    v_lshrrev_b32 v2, 16, v2
    v_mul_u32_u24 v3, 3, v2
    v_sub_u32 v3, v1, v3
    v_add_u32 v2, s33, v2
    v_mul_u32_u24 v2, 1152, v2
    v_lshl_add_u32 v2, v3, 7, v2
    v_add_u32 v2, 768, v2
    buffer_load_dword v29, v2, s[4:7], s91 offen
    v_add_u32 v4, 64, v1
    v_min_u32 v4, 95, v4
    v_mul_u32_u24 v2, 21846, v4
    v_lshrrev_b32 v2, 16, v2
    v_mul_u32_u24 v3, 3, v2
    v_sub_u32 v3, v4, v3
    v_add_u32 v2, s33, v2
    v_mul_u32_u24 v2, 1152, v2
    v_lshl_add_u32 v2, v3, 7, v2
    v_add_u32 v2, 768, v2
    buffer_load_dword v29, v2, s[4:7], s91 offen
    s_and_b32 s33, s16, 7
    s_mul_i32 s33, s33, 144

    v_min_u32 v4, 47, v1
    v_add_u32 v4, 0, v4
    v_add_u32 v4, s33, v4
    v_mul_u32_u24 v2, 21846, v4
    v_lshrrev_b32 v2, 22, v2
    v_mul_u32_u24 v3, 192, v2
    v_sub_u32 v3, v4, v3
    v_add_u32 v2, 2, v2
    v_mul_u32_u24 v5, 21846, v2
    v_lshrrev_b32 v5, 16, v5
    v_mul_u32_u24 v6, 3, v5
    v_sub_u32 v6, v2, v6
    v_mul_u32_u24 v6, 192, v6
    v_add_u32 v3, v3, v6
    v_mul_u32_u24 v3, 9216, v3
    v_lshl_add_u32 v3, v5, 7, v3
    buffer_load_dword v29, v3, s[8:11], 0 offen

    v_min_u32 v4, 47, v1
    v_add_u32 v4, 48, v4
    v_add_u32 v4, s33, v4
    v_mul_u32_u24 v2, 21846, v4
    v_lshrrev_b32 v2, 22, v2
    v_mul_u32_u24 v3, 192, v2
    v_sub_u32 v3, v4, v3
    v_add_u32 v2, 2, v2
    v_mul_u32_u24 v5, 21846, v2
    v_lshrrev_b32 v5, 16, v5
    v_mul_u32_u24 v6, 3, v5
    v_sub_u32 v6, v2, v6
    v_mul_u32_u24 v6, 192, v6
    v_add_u32 v3, v3, v6
    v_mul_u32_u24 v3, 9216, v3
    v_lshl_add_u32 v3, v5, 7, v3
    buffer_load_dword v29, v3, s[8:11], 0 offen

    v_min_u32 v4, 47, v1
    v_add_u32 v4, 96, v4
    v_add_u32 v4, s33, v4
    v_mul_u32_u24 v2, 21846, v4
    v_lshrrev_b32 v2, 22, v2
    v_mul_u32_u24 v3, 192, v2
    v_sub_u32 v3, v4, v3
    v_add_u32 v2, 2, v2
    v_mul_u32_u24 v5, 21846, v2
    v_lshrrev_b32 v5, 16, v5
    v_mul_u32_u24 v6, 3, v5
    v_sub_u32 v6, v2, v6
    v_mul_u32_u24 v6, 192, v6
    v_add_u32 v3, v3, v6
    v_mul_u32_u24 v3, 9216, v3
    v_lshl_add_u32 v3, v5, 7, v3
    buffer_load_dword v29, v3, s[8:11], 0 offen

gated_mix__ssm_conv_h3__dense_activation_gelu__prompt_kernel_nopt:
    s_mov_b32 s12, s42
    s_mov_b32 s13, s43
    s_mov_b32 s14, 24117248
    s_mov_b32 s15, 0x00020000
    s_add_u32 s92, s42, 45088768
    s_addc_u32 s93, s43, 0
    s_mov_b32 s94, 107520
    s_mov_b32 s95, 0x00020000
    s_mov_b32 s44, s58
    s_mov_b32 s45, s59
    s_mov_b32 s46, 256
    s_mov_b32 s47, 0x00020000
    s_or_b32 s33, s2, s98
    s_cmp_lg_u32 s33, 0
    s_cbranch_scc1 gated_mix__ssm_conv_h3__dense_activation_gelu__prompt_kernel_nonce_skip
    s_memrealtime s[34:35]
    s_waitcnt lgkmcnt(0)
    s_or_b32 s34, s34, 1
    v_mov_b32 v2, s34
    v_mov_b32 v3, s35
    v_mov_b32 v4, 0
    s_mov_b64 s[30:31], exec
    s_mov_b64 exec, 1
    buffer_store_dwordx2 v[2:3], v4, s[44:47], 0 offen sc1
    s_mov_b64 exec, s[30:31]

gated_mix__ssm_conv_h3__dense_activation_gelu__prompt_kernel_nonce_skip:
    s_mov_b32 s19, 0
    s_cmp_lt_u32 s23, 9
    s_cselect_b32 s19, 1, 0
    s_cmp_eq_u32 s3, 3
    s_cselect_b32 s19, 2, s19

    s_cmp_eq_u32 s19, 2
    s_cbranch_scc1 gated_mix__ssm_conv_h3__dense_activation_gelu__prompt_kernel_gsrd
    s_mov_b32 s60, s50
    s_mov_b32 s61, s51
    s_mov_b32 s62, 2359296
    s_mov_b32 s63, 0x00020000
    s_mov_b32 s64, s52
    s_mov_b32 s65, s53
    s_mov_b32 s66, 2359296
    s_mov_b32 s67, 0x00020000
    s_mov_b32 s68, s54
    s_mov_b32 s69, s55
    s_mov_b32 s70, 4608
    s_mov_b32 s71, 0x00020000
    s_branch gated_mix__ssm_conv_h3__dense_activation_gelu__prompt_kernel_gsrde
gated_mix__ssm_conv_h3__dense_activation_gelu__prompt_kernel_gsrd:
    s_mov_b32 s60, s48
    s_mov_b32 s61, s49
    s_mov_b32 s62, 2359296
    s_mov_b32 s63, 0x00020000
    s_mov_b32 s64, s56
    s_mov_b32 s65, s57
    s_mov_b32 s66, 1152
    s_mov_b32 s67, 0x00020000
    s_mov_b32 s68, s60
    s_mov_b32 s69, s61
    s_mov_b32 s70, s62
    s_mov_b32 s71, 0x00020000
gated_mix__ssm_conv_h3__dense_activation_gelu__prompt_kernel_gsrde:
    s_load_dwordx2 s[52:53], s[0:1], 72
    s_load_dwordx2 s[54:55], s[0:1], 96
    s_load_dwordx2 s[56:57], s[0:1], 32
    v_and_b32 v3, 31, v1
    v_lshrrev_b32 v4, 5, v1
    v_bfe_u32 v5, v3, 1, 3
    v_xor_b32 v5, v4, v5
    v_lshlrev_b32 v5, 4, v5
    v_lshl_add_u32 v5, v3, 7, v5
    s_lshl_b32 s33, s20, 12
    v_add_u32 v24, s33, v5
    v_xor_b32 v25, 32, v24
    v_xor_b32 v26, 64, v24
    v_xor_b32 v27, 96, v24
    v_bfe_u32 v6, v1, 2, 2
    v_lshl_add_u32 v7, v4, 3, v6
    v_lshlrev_b32 v7, 7, v7
    v_lshrrev_b32 v6, 1, v6
    v_xor_b32 v6, s21, v6
    v_lshl_add_u32 v7, v6, 6, v7
    v_bfe_u32 v6, v1, 4, 1
    v_lshl_add_u32 v7, v6, 5, v7
    v_and_b32 v6, 3, v1
    v_lshl_add_u32 v30, v6, 3, v7
    v_add_u32 v31, 49152, v30
    v_add_u32 v32, 98304, v30
    s_and_b32 s35, s17, 1
    s_lshl_b32 s33, s21, 7
    s_add_u32 s33, s33, 155648
    s_lshl_b32 s34, s35, 8
    s_add_u32 s33, s33, s34
    v_lshlrev_b32 v37, 4, v4
    v_add_u32 v37, s33, v37
    v_mov_b32 v38, 0xbdd2d3e8
    s_movk_i32 s33, 128
    s_movk_i32 s34, 256
    s_cmp_eq_u32 s35, 0
    s_cselect_b32 s50, s33, -512
    s_cselect_b32 s51, 0, -1
    s_cselect_b32 s48, s34, -896
    s_lshl_b32 s49, s35, 6
    s_mul_i32 s27, s16, 1179648
    s_lshl_b32 s33, s20, 11
    s_add_u32 s27, s27, s33
    s_add_u32 s27, s27, 5242880
    s_lshl_b32 s33, s18, 1
    s_add_u32 s34, s33, 8
    s_add_u32 s33, s33, 1
    s_cmp_eq_u32 s35, 0
    s_cselect_b32 s33, s34, s33
    s_lshl_b32 s33, s33, 13
    s_add_u32 s59, s27, s33
    s_add_u32 s33, s18, s35
    s_lshl_b32 s33, s33, 1
    s_add_u32 s33, s33, s21
    s_lshl_b32 s33, s33, 13
    s_add_u32 s27, s27, s33
    s_sub_u32 s27, s27, 16384
    s_lshl_b32 s32, s98, 11
    s_add_u32 s32, s32, 4784128
    s_mov_b32 s25, 0
    s_mov_b32 s26, s32

    s_cmp_eq_u32 s98, 7
    s_cbranch_scc1 gated_mix__ssm_conv_h3__dense_activation_gelu__prompt_kernel_wa7
    s_cmp_eq_u32 s98, 6
    s_cbranch_scc1 gated_mix__ssm_conv_h3__dense_activation_gelu__prompt_kernel_wa6
    s_waitcnt vmcnt(9)
    s_branch gated_mix__ssm_conv_h3__dense_activation_gelu__prompt_kernel_wad
    gated_mix__ssm_conv_h3__dense_activation_gelu__prompt_kernel_wa6:
    s_waitcnt vmcnt(9)
    s_branch gated_mix__ssm_conv_h3__dense_activation_gelu__prompt_kernel_wad
    gated_mix__ssm_conv_h3__dense_activation_gelu__prompt_kernel_wa7:
    s_waitcnt vmcnt(14)
    gated_mix__ssm_conv_h3__dense_activation_gelu__prompt_kernel_wad:
    v_lshlrev_b32 v39, 16, v39
    v_lshlrev_b32 v33, 2, v0
    v_add_u32 v33, 155648, v33
    v_cmp_gt_u32 vcc, 320, v0
    s_and_saveexec_b64 s[30:31], vcc
    s_cbranch_execz gated_mix__ssm_conv_h3__dense_activation_gelu__prompt_kernel_nobias
    ds_write_b32 v33, v39

gated_mix__ssm_conv_h3__dense_activation_gelu__prompt_kernel_nobias:
    s_mov_b64 exec, s[30:31]
    s_waitcnt lgkmcnt(0)
    s_barrier
    ds_read_b128 v[112:115], v24 offset:49152
    ds_read_b128 v[116:119], v25 offset:49152
    ds_read_b128 v[120:123], v26 offset:49152
    ds_read_b128 v[124:127], v27 offset:49152
    v_add_u32 v28, 65536, v24
    ds_read_b128 v[128:131], v28
    v_add_u32 v28, 65536, v25
    ds_read_b128 v[132:135], v28
    v_add_u32 v28, 65536, v26
    ds_read_b128 v[136:139], v28
    v_add_u32 v28, 65536, v27
    ds_read_b128 v[140:143], v28
    v_add_u32 v28, 81920, v24
    ds_read_b128 v[144:147], v28
    v_add_u32 v28, 81920, v25
    ds_read_b128 v[148:151], v28
    v_add_u32 v28, 81920, v26
    ds_read_b128 v[152:155], v28
    v_add_u32 v28, 81920, v27
    ds_read_b128 v[156:159], v28
    ds_read_b128 v[8:11], v37 offset:0
    ds_read_b128 v[12:15], v37 offset:32
    ds_read_b128 v[16:19], v37 offset:64
    ds_read_b128 v[20:23], v37 offset:96
    s_waitcnt lgkmcnt(0)
    s_barrier
    s_add_u32 m0, s22, 49152
    s_nop 0
    buffer_load_dwordx4 v34, s[8:11], s86 offen lds
    s_add_u32 m0, s22, 50176
    s_nop 0
    buffer_load_dwordx4 v34, s[8:11], s87 offen lds
    s_add_u32 m0, s22, 51200
    s_nop 0
    buffer_load_dwordx4 v34, s[8:11], s88 offen lds
    s_add_u32 s8, s8, 128
    s_addc_u32 s9, s9, 0
    s_add_u32 m0, s22, 73728
    s_nop 0
    buffer_load_dwordx4 v34, s[8:11], s80 offen lds
    s_add_u32 m0, s22, 74752
    s_nop 0
    buffer_load_dwordx4 v34, s[8:11], s81 offen lds
    s_add_u32 m0, s22, 75776
    s_nop 0
    buffer_load_dwordx4 v34, s[8:11], s82 offen lds
    ds_read_b64_tr_b16 v[56:57], v30 offset:0
    ds_read_b64_tr_b16 v[58:59], v30 offset:512
    ds_read_b64_tr_b16 v[60:61], v30 offset:2048
    ds_read_b64_tr_b16 v[62:63], v30 offset:2560
    ds_read_b64_tr_b16 v[64:65], v30 offset:4096
    ds_read_b64_tr_b16 v[66:67], v30 offset:4608
    ds_read_b64_tr_b16 v[68:69], v30 offset:6144
    ds_read_b64_tr_b16 v[70:71], v30 offset:6656
    s_waitcnt lgkmcnt(6)
    v_mfma_f32_32x32x16_bf16 v[80:95], v[56:59], v[112:115], v[8:23]
    ds_read_b64_tr_b16 v[72:73], v30 offset:8192
    ds_read_b64_tr_b16 v[74:75], v30 offset:8704
    s_waitcnt lgkmcnt(6)
    v_mfma_f32_32x32x16_bf16 v[80:95], v[60:63], v[116:119], v[80:95]
    ds_read_b64_tr_b16 v[76:77], v30 offset:10240
    ds_read_b64_tr_b16 v[78:79], v30 offset:10752
    s_waitcnt lgkmcnt(6)
    v_mfma_f32_32x32x16_bf16 v[80:95], v[64:67], v[120:123], v[80:95]
    ds_read_b64_tr_b16 v[56:57], v30 offset:12288
    ds_read_b64_tr_b16 v[58:59], v30 offset:12800
    s_waitcnt lgkmcnt(6)
    v_mfma_f32_32x32x16_bf16 v[80:95], v[68:71], v[124:127], v[80:95]
    ds_read_b64_tr_b16 v[60:61], v30 offset:14336
    ds_read_b64_tr_b16 v[62:63], v30 offset:14848
    s_waitcnt lgkmcnt(6)
    v_mfma_f32_32x32x16_bf16 v[80:95], v[72:75], v[128:131], v[80:95]
    ds_read_b64_tr_b16 v[64:65], v30 offset:16384
    ds_read_b64_tr_b16 v[66:67], v30 offset:16896
    s_waitcnt lgkmcnt(6)
    v_mfma_f32_32x32x16_bf16 v[80:95], v[76:79], v[132:135], v[80:95]
    ds_read_b64_tr_b16 v[68:69], v30 offset:18432
    ds_read_b64_tr_b16 v[70:71], v30 offset:18944
    s_waitcnt lgkmcnt(6)
    v_mfma_f32_32x32x16_bf16 v[80:95], v[56:59], v[136:139], v[80:95]
    ds_read_b64_tr_b16 v[72:73], v30 offset:20480
    ds_read_b64_tr_b16 v[74:75], v30 offset:20992
    s_waitcnt lgkmcnt(6)
    v_mfma_f32_32x32x16_bf16 v[80:95], v[60:63], v[140:143], v[80:95]
    ds_read_b64_tr_b16 v[76:77], v30 offset:22528
    ds_read_b64_tr_b16 v[78:79], v30 offset:23040
    s_waitcnt lgkmcnt(6)
    v_mfma_f32_32x32x16_bf16 v[80:95], v[64:67], v[144:147], v[80:95]
    s_waitcnt lgkmcnt(4)
    v_mfma_f32_32x32x16_bf16 v[80:95], v[68:71], v[148:151], v[80:95]
    s_waitcnt lgkmcnt(2)
    v_mfma_f32_32x32x16_bf16 v[80:95], v[72:75], v[152:155], v[80:95]
    s_waitcnt lgkmcnt(0)
    v_mfma_f32_32x32x16_bf16 v[80:95], v[76:79], v[156:159], v[80:95]
    s_cmp_eq_u32 s98, 7
    s_cbranch_scc1 gated_mix__ssm_conv_h3__dense_activation_gelu__prompt_kernel_wb11
    s_cmp_eq_u32 s98, 6
    s_cbranch_scc1 gated_mix__ssm_conv_h3__dense_activation_gelu__prompt_kernel_wb9
    s_waitcnt vmcnt(6)
    s_branch gated_mix__ssm_conv_h3__dense_activation_gelu__prompt_kernel_wbd
gated_mix__ssm_conv_h3__dense_activation_gelu__prompt_kernel_wb9:
    s_waitcnt vmcnt(6)
    s_branch gated_mix__ssm_conv_h3__dense_activation_gelu__prompt_kernel_wbd
gated_mix__ssm_conv_h3__dense_activation_gelu__prompt_kernel_wb11:
    s_waitcnt vmcnt(11)
gated_mix__ssm_conv_h3__dense_activation_gelu__prompt_kernel_wbd:
    s_barrier
    v_add_u32 v28, 98304, v24
    ds_read_b128 v[160:163], v28
    v_add_u32 v28, 98304, v25
    ds_read_b128 v[164:167], v28
    v_add_u32 v28, 98304, v26
    ds_read_b128 v[168:171], v28
    v_add_u32 v28, 98304, v27
    ds_read_b128 v[172:175], v28
    v_add_u32 v28, 114688, v24
    ds_read_b128 v[176:179], v28
    v_add_u32 v28, 114688, v25
    ds_read_b128 v[180:183], v28
    v_add_u32 v28, 114688, v26
    ds_read_b128 v[184:187], v28
    v_add_u32 v28, 114688, v27
    ds_read_b128 v[188:191], v28
    v_add_u32 v28, 131072, v24
    ds_read_b128 v[192:195], v28
    v_add_u32 v28, 131072, v25
    ds_read_b128 v[196:199], v28
    v_add_u32 v28, 131072, v26
    ds_read_b128 v[200:203], v28
    v_add_u32 v28, 131072, v27
    ds_read_b128 v[204:207], v28
    s_waitcnt lgkmcnt(0)
    s_barrier
    s_lshl_b32 s30, s98, 10
    s_add_u32 m0, s30, 98304
    s_add_u32 s29, s91, 768
    buffer_load_dwordx4 v35, s[4:7], s29 offen lds
    s_lshl_b32 s30, s98, 10
    s_add_u32 m0, s30, 106496
    s_add_u32 s29, s91, 74496
    buffer_load_dwordx4 v35, s[4:7], s29 offen lds
    s_lshl_b32 s30, s98, 10
    s_add_u32 m0, s30, 114688
    s_add_u32 s29, s91, 896
    buffer_load_dwordx4 v35, s[4:7], s29 offen lds
    s_lshl_b32 s30, s98, 10
    s_add_u32 m0, s30, 122880
    s_add_u32 s29, s91, 74624
    buffer_load_dwordx4 v35, s[4:7], s29 offen lds
    s_lshl_b32 s30, s98, 10
    s_add_u32 m0, s30, 131072
    s_add_u32 s29, s91, 1024
    buffer_load_dwordx4 v35, s[4:7], s29 offen lds
    s_lshl_b32 s30, s98, 10
    s_add_u32 m0, s30, 139264
    s_add_u32 s29, s91, 74752
    buffer_load_dwordx4 v35, s[4:7], s29 offen lds
    s_cmp_lg_u32 s98, 7
    s_cbranch_scc1 gated_mix__ssm_conv_h3__dense_activation_gelu__prompt_kernel_nonl
    s_load_dwordx2 s[34:35], s[0:1], 104
    s_waitcnt lgkmcnt(0)
    s_mov_b32 s44, s34
    s_mov_b32 s45, s35
    s_mov_b32 s46, 256
    s_mov_b32 s47, 0x00020000
    v_mov_b32 v39, 0
    buffer_load_dwordx2 v[52:53], v39, s[44:47], 0 offen sc1
    gated_mix__ssm_conv_h3__dense_activation_gelu__prompt_kernel_nonl:

    ds_read_b64_tr_b16 v[56:57], v30 offset:24576
    ds_read_b64_tr_b16 v[58:59], v30 offset:25088
    ds_read_b64_tr_b16 v[60:61], v30 offset:26624
    ds_read_b64_tr_b16 v[62:63], v30 offset:27136
    ds_read_b64_tr_b16 v[64:65], v30 offset:28672
    ds_read_b64_tr_b16 v[66:67], v30 offset:29184
    ds_read_b64_tr_b16 v[68:69], v30 offset:30720
    ds_read_b64_tr_b16 v[70:71], v30 offset:31232
    s_waitcnt lgkmcnt(6)
    v_mfma_f32_32x32x16_bf16 v[80:95], v[56:59], v[160:163], v[80:95]
    ds_read_b64_tr_b16 v[72:73], v30 offset:32768
    ds_read_b64_tr_b16 v[74:75], v30 offset:33280
    s_waitcnt lgkmcnt(6)
    v_mfma_f32_32x32x16_bf16 v[80:95], v[60:63], v[164:167], v[80:95]
    ds_read_b64_tr_b16 v[76:77], v30 offset:34816
    ds_read_b64_tr_b16 v[78:79], v30 offset:35328
    s_waitcnt lgkmcnt(6)
    v_mfma_f32_32x32x16_bf16 v[80:95], v[64:67], v[168:171], v[80:95]
    ds_read_b64_tr_b16 v[56:57], v30 offset:36864
    ds_read_b64_tr_b16 v[58:59], v30 offset:37376
    s_waitcnt lgkmcnt(6)
    v_mfma_f32_32x32x16_bf16 v[80:95], v[68:71], v[172:175], v[80:95]
    ds_read_b64_tr_b16 v[60:61], v30 offset:38912
    ds_read_b64_tr_b16 v[62:63], v30 offset:39424
    s_waitcnt lgkmcnt(6)
    v_mfma_f32_32x32x16_bf16 v[80:95], v[72:75], v[176:179], v[80:95]
    ds_read_b64_tr_b16 v[64:65], v30 offset:40960
    ds_read_b64_tr_b16 v[66:67], v30 offset:41472
    s_waitcnt lgkmcnt(6)
    v_mfma_f32_32x32x16_bf16 v[80:95], v[76:79], v[180:183], v[80:95]
    ds_read_b64_tr_b16 v[68:69], v30 offset:43008
    ds_read_b64_tr_b16 v[70:71], v30 offset:43520
    s_waitcnt lgkmcnt(6)
    v_mfma_f32_32x32x16_bf16 v[80:95], v[56:59], v[184:187], v[80:95]
    ds_read_b64_tr_b16 v[72:73], v30 offset:45056
    ds_read_b64_tr_b16 v[74:75], v30 offset:45568
    s_waitcnt lgkmcnt(6)
    v_mfma_f32_32x32x16_bf16 v[80:95], v[60:63], v[188:191], v[80:95]
    ds_read_b64_tr_b16 v[76:77], v30 offset:47104
    ds_read_b64_tr_b16 v[78:79], v30 offset:47616
    s_waitcnt lgkmcnt(6)
    v_mfma_f32_32x32x16_bf16 v[80:95], v[64:67], v[192:195], v[80:95]
    s_waitcnt lgkmcnt(4)
    v_mfma_f32_32x32x16_bf16 v[80:95], v[68:71], v[196:199], v[80:95]
    s_waitcnt lgkmcnt(2)
    v_mfma_f32_32x32x16_bf16 v[80:95], v[72:75], v[200:203], v[80:95]
    s_waitcnt lgkmcnt(0)
    v_mfma_f32_32x32x16_bf16 v[80:95], v[76:79], v[204:207], v[80:95]
    s_cmp_eq_u32 s19, 1
    s_cbranch_scc0 gated_mix__ssm_conv_h3__dense_activation_gelu__prompt_kernel_noTl
    v_and_b32 v2, 7, v0
    v_lshrrev_b32 v3, 3, v0
    s_lshl_b32 s33, s16, 7
    v_lshlrev_b32 v4, 1, v3
    v_add_u32 v4, s33, v4
    s_movk_i32 s33, 1152
    v_mul_lo_u32 v5, v4, s33
    s_lshl_b32 s33, s23, 7
    v_lshl_add_u32 v5, v2, 4, v5
    v_add_u32 v5, s33, v5
    v_subrev_u32 v6, 3456, v5
    v_subrev_u32 v7, 2304, v5
    buffer_load_dwordx4 v[96:99], v6, s[60:63], 0 offen
    buffer_load_dwordx4 v[100:103], v7, s[60:63], 0 offen
    v_subrev_u32 v6, 1152, v5
    v_add_u32 v7, 1152, v5
    buffer_load_dwordx4 v[104:107], v6, s[60:63], 0 offen
    buffer_load_dwordx4 v[108:111], v5, s[60:63], 0 offen
    buffer_load_dwordx4 v[40:43], v7, s[60:63], 0 offen
    buffer_load_dwordx4 v[44:47], v5, s[64:67], 0 offen
    buffer_load_dwordx4 v[48:51], v7, s[64:67], 0 offen
    s_lshl_b32 s33, s23, 9
    v_lshlrev_b32 v6, 6, v2
    v_add_u32 v6, s33, v6
    buffer_load_dwordx4 v[8:11], v6, s[68:71], 0 offen
    buffer_load_dwordx4 v[12:15], v6, s[68:71], 0 offen offset:16
    buffer_load_dwordx4 v[16:19], v6, s[68:71], 0 offen offset:32
    buffer_load_dwordx4 v[20:23], v6, s[68:71], 0 offen offset:48

gated_mix__ssm_conv_h3__dense_activation_gelu__prompt_kernel_noTl:
    s_cmp_eq_u32 s19, 1
    s_cbranch_scc1 gated_mix__ssm_conv_h3__dense_activation_gelu__prompt_kernel_w11
    s_waitcnt vmcnt(0)
    s_branch gated_mix__ssm_conv_h3__dense_activation_gelu__prompt_kernel_wd
    gated_mix__ssm_conv_h3__dense_activation_gelu__prompt_kernel_w11:
    s_waitcnt vmcnt(11)
    gated_mix__ssm_conv_h3__dense_activation_gelu__prompt_kernel_wd:
    v_readfirstlane_b32 s46, v52
    v_readfirstlane_b32 s47, v53
    s_barrier

    v_add_u32 v28, 98304, v24
    ds_read_b128 v[208:211], v28
    v_add_u32 v28, 98304, v25
    ds_read_b128 v[212:215], v28
    v_add_u32 v28, 98304, v26
    ds_read_b128 v[216:219], v28
    v_add_u32 v28, 98304, v27
    ds_read_b128 v[220:223], v28
    v_add_u32 v28, 114688, v24
    ds_read_b128 v[224:227], v28
    v_add_u32 v28, 114688, v25
    ds_read_b128 v[228:231], v28
    v_add_u32 v28, 114688, v26
    ds_read_b128 v[232:235], v28
    v_add_u32 v28, 114688, v27
    ds_read_b128 v[236:239], v28
    v_add_u32 v28, 131072, v24
    ds_read_b128 v[240:243], v28
    v_add_u32 v28, 131072, v25
    ds_read_b128 v[244:247], v28
    v_add_u32 v28, 131072, v26
    ds_read_b128 v[248:251], v28
    v_add_u32 v28, 131072, v27
    ds_read_b128 v[252:255], v28
    s_waitcnt lgkmcnt(0)
    s_barrier
    s_add_u32 m0, s22, 98304
    s_nop 0
    buffer_load_dwordx4 v34, s[8:11], s83 offen lds
    s_add_u32 m0, s22, 99328
    s_nop 0
    buffer_load_dwordx4 v34, s[8:11], s84 offen lds
    s_add_u32 m0, s22, 100352
    s_nop 0
    buffer_load_dwordx4 v34, s[8:11], s85 offen lds
    s_add_u32 m0, s22, 122880
    s_nop 0
    buffer_load_dwordx4 v34, s[8:11], s86 offen lds
    s_add_u32 m0, s22, 123904
    s_nop 0
    buffer_load_dwordx4 v34, s[8:11], s87 offen lds
    s_add_u32 m0, s22, 124928
    s_nop 0
    buffer_load_dwordx4 v34, s[8:11], s88 offen lds
    s_cmp_eq_u32 s19, 1
    s_cbranch_scc0 gated_mix__ssm_conv_h3__dense_activation_gelu__prompt_kernel_noTc
    v_and_b32 v2, 7, v0
    v_lshrrev_b32 v3, 3, v0
    v_and_b32 v54, 1, v3
    v_bfe_u32 v55, v3, 2, 1
    v_lshl_or_b32 v54, v55, 1, v54
    v_lshlrev_b32 v54, 1, v54
    v_xor_b32 v54, v2, v54
    v_lshlrev_b32 v54, 4, v54
    v_lshl_add_u32 v54, v3, 8, v54
    v_add_u32 v54, 24576, v54
    s_mov_b32 s33, 0xffff0000
    s_waitcnt vmcnt(6)

    s_mov_b32 s34, 0x05040100
    s_mov_b32 s35, 0x07060302
    v_perm_b32 v2, v104, v108, s34
    v_perm_b32 v3, v96, v100, s34
    v_perm_b32 v4, v108, v40, s34
    v_perm_b32 v5, v100, v104, s34
    v_dot2_f32_bf16 v6, v3, v9, 0
    v_dot2_f32_bf16 v7, v5, v9, 0
    v_dot2_f32_bf16 v6, v2, v8, v6
    v_dot2_f32_bf16 v7, v4, v8, v7

    v_lshlrev_b32 v29, 16, v44
    v_lshlrev_b32 v33, 16, v48
    s_nop 0
    v_cvt_pk_bf16_f32 v39, v6, v7
    v_lshlrev_b32 v6, 16, v39
    v_and_b32 v7, s33, v39
    v_mul_f32 v52, v6, v29
    v_mul_f32 v55, v7, v33

    v_perm_b32 v2, v104, v108, s35
    v_perm_b32 v3, v96, v100, s35
    v_perm_b32 v4, v108, v40, s35
    v_perm_b32 v5, v100, v104, s35
    v_dot2_f32_bf16 v6, v3, v11, 0
    v_dot2_f32_bf16 v7, v5, v11, 0
    v_dot2_f32_bf16 v6, v2, v10, v6
    v_dot2_f32_bf16 v7, v4, v10, v7

    v_and_b32 v29, s33, v44
    v_and_b32 v33, s33, v48
    s_nop 0
    v_cvt_pk_bf16_f32 v39, v6, v7
    v_lshlrev_b32 v6, 16, v39
    v_and_b32 v7, s33, v39
    v_mul_f32 v53, v6, v29
    v_mul_f32 v28, v7, v33

    v_cvt_pk_bf16_f32 v96, v52, v53
    v_cvt_pk_bf16_f32 v100, v55, v28
    v_perm_b32 v2, v105, v109, s34
    v_perm_b32 v3, v97, v101, s34
    v_perm_b32 v4, v109, v41, s34
    v_perm_b32 v5, v101, v105, s34
    v_dot2_f32_bf16 v6, v3, v13, 0
    v_dot2_f32_bf16 v7, v5, v13, 0
    v_dot2_f32_bf16 v6, v2, v12, v6
    v_dot2_f32_bf16 v7, v4, v12, v7

    v_lshlrev_b32 v29, 16, v45
    v_lshlrev_b32 v33, 16, v49
    s_nop 0
    v_cvt_pk_bf16_f32 v39, v6, v7
    v_lshlrev_b32 v6, 16, v39
    v_and_b32 v7, s33, v39
    v_mul_f32 v52, v6, v29
    v_mul_f32 v55, v7, v33

    v_perm_b32 v2, v105, v109, s35
    v_perm_b32 v3, v97, v101, s35
    v_perm_b32 v4, v109, v41, s35
    v_perm_b32 v5, v101, v105, s35
    v_dot2_f32_bf16 v6, v3, v15, 0
    v_dot2_f32_bf16 v7, v5, v15, 0
    v_dot2_f32_bf16 v6, v2, v14, v6
    v_dot2_f32_bf16 v7, v4, v14, v7

    v_and_b32 v29, s33, v45
    v_and_b32 v33, s33, v49
    s_nop 0
    v_cvt_pk_bf16_f32 v39, v6, v7
    v_lshlrev_b32 v6, 16, v39
    v_and_b32 v7, s33, v39
    v_mul_f32 v53, v6, v29
    v_mul_f32 v28, v7, v33

    v_cvt_pk_bf16_f32 v97, v52, v53
    v_cvt_pk_bf16_f32 v101, v55, v28
    v_perm_b32 v2, v106, v110, s34
    v_perm_b32 v3, v98, v102, s34
    v_perm_b32 v4, v110, v42, s34
    v_perm_b32 v5, v102, v106, s34
    v_dot2_f32_bf16 v6, v3, v17, 0
    v_dot2_f32_bf16 v7, v5, v17, 0
    v_dot2_f32_bf16 v6, v2, v16, v6
    v_dot2_f32_bf16 v7, v4, v16, v7

    v_lshlrev_b32 v29, 16, v46
    v_lshlrev_b32 v33, 16, v50
    s_nop 0
    v_cvt_pk_bf16_f32 v39, v6, v7
    v_lshlrev_b32 v6, 16, v39
    v_and_b32 v7, s33, v39
    v_mul_f32 v52, v6, v29
    v_mul_f32 v55, v7, v33

    v_perm_b32 v2, v106, v110, s35
    v_perm_b32 v3, v98, v102, s35
    v_perm_b32 v4, v110, v42, s35
    v_perm_b32 v5, v102, v106, s35
    v_dot2_f32_bf16 v6, v3, v19, 0
    v_dot2_f32_bf16 v7, v5, v19, 0
    v_dot2_f32_bf16 v6, v2, v18, v6
    v_dot2_f32_bf16 v7, v4, v18, v7

    v_and_b32 v29, s33, v46
    v_and_b32 v33, s33, v50
    s_nop 0
    v_cvt_pk_bf16_f32 v39, v6, v7
    v_lshlrev_b32 v6, 16, v39
    v_and_b32 v7, s33, v39
    v_mul_f32 v53, v6, v29
    v_mul_f32 v28, v7, v33

    v_cvt_pk_bf16_f32 v98, v52, v53
    v_cvt_pk_bf16_f32 v102, v55, v28
    v_perm_b32 v2, v107, v111, s34
    v_perm_b32 v3, v99, v103, s34
    v_perm_b32 v4, v111, v43, s34
    v_perm_b32 v5, v103, v107, s34
    v_dot2_f32_bf16 v6, v3, v21, 0
    v_dot2_f32_bf16 v7, v5, v21, 0
    v_dot2_f32_bf16 v6, v2, v20, v6
    v_dot2_f32_bf16 v7, v4, v20, v7

    v_lshlrev_b32 v29, 16, v47
    v_lshlrev_b32 v33, 16, v51
    s_nop 0
    v_cvt_pk_bf16_f32 v39, v6, v7
    v_lshlrev_b32 v6, 16, v39
    v_and_b32 v7, s33, v39
    v_mul_f32 v52, v6, v29
    v_mul_f32 v55, v7, v33

    v_perm_b32 v2, v107, v111, s35
    v_perm_b32 v3, v99, v103, s35
    v_perm_b32 v4, v111, v43, s35
    v_perm_b32 v5, v103, v107, s35
    v_dot2_f32_bf16 v6, v3, v23, 0
    v_dot2_f32_bf16 v7, v5, v23, 0
    v_dot2_f32_bf16 v6, v2, v22, v6
    v_dot2_f32_bf16 v7, v4, v22, v7

    v_and_b32 v29, s33, v47
    v_and_b32 v33, s33, v51
    s_nop 0
    v_cvt_pk_bf16_f32 v39, v6, v7
    v_lshlrev_b32 v6, 16, v39
    v_and_b32 v7, s33, v39
    v_mul_f32 v53, v6, v29
    v_mul_f32 v28, v7, v33

    v_cvt_pk_bf16_f32 v99, v52, v53
    v_cvt_pk_bf16_f32 v103, v55, v28
    ds_write_b128 v54, v[96:99]
    ds_write_b128 v54, v[100:103] offset:128
    s_waitcnt lgkmcnt(0)
    s_barrier

    v_lshrrev_b32 v2, 6, v0
    v_lshrrev_b32 v3, 4, v1
    v_and_b32 v4, 15, v1
    v_lshrrev_b32 v5, 2, v4
    v_and_b32 v6, 3, v4
    v_and_b32 v7, 3, v2
    v_lshrrev_b32 v8, 2, v2
    v_lshrrev_b32 v9, 1, v5
    v_sub_u32 v9, 1, v9
    v_and_b32 v10, 1, v3
    v_lshl_or_b32 v9, v10, 1, v9
    v_lshlrev_b32 v9, 1, v9
    v_lshrrev_b32 v10, 1, v6
    v_lshl_add_u32 v10, v7, 1, v10
    v_xor_b32 v10, v10, v9
    v_lshlrev_b32 v10, 4, v10
    v_and_b32 v11, 1, v6
    v_lshl_add_u32 v10, v11, 3, v10
    v_lshl_add_u32 v11, v8, 3, v3
    v_lshlrev_b32 v12, 3, v11
    v_add_u32 v12, 7, v12
    v_sub_u32 v12, v12, v5
    v_lshl_add_u32 v10, v12, 7, v10
    v_add_u32 v10, 24576, v10
    v_subrev_u32 v13, 512, v10
    ds_read_b64_tr_b16 v[40:41], v10
    ds_read_b64_tr_b16 v[42:43], v13
    ds_read_b64_tr_b16 v[44:45], v10 offset:4096
    ds_read_b64_tr_b16 v[46:47], v13 offset:4096
    v_lshl_add_u32 v14, v7, 4, v4
    s_lshl_b32 s33, s23, 6
    v_add_u32 v14, s33, v14
    v_lshlrev_b32 v14, 12, v14
    s_lshl_b32 s33, s16, 8
    s_sub_u32 s33, 4080, s33
    v_lshlrev_b32 v15, 4, v11
    v_sub_u32 v15, s33, v15
    v_add_u32 v52, v14, v15
    v_subrev_u32 v53, 64, v52

    s_waitcnt lgkmcnt(0)
    s_barrier
gated_mix__ssm_conv_h3__dense_activation_gelu__prompt_kernel_noTc:
    s_cmp_lg_u32 s98, 7
    s_cbranch_scc1 gated_mix__ssm_conv_h3__dense_activation_gelu__prompt_kernel_nopf
    s_mov_b32 s34, s46
    s_mov_b32 s35, s47
    s_cmp_eq_u32 s34, 0
    s_cbranch_scc0 gated_mix__ssm_conv_h3__dense_activation_gelu__prompt_kernel_gotn

    s_load_dwordx2 s[34:35], s[0:1], 104
    s_waitcnt lgkmcnt(0)
    s_mov_b32 s44, s34
    s_mov_b32 s45, s35
    s_mov_b32 s46, 256
    s_mov_b32 s47, 0x00020000
    v_mov_b32 v4, 0
    s_mov_b32 s33, 0
    Lng1:
    buffer_load_dwordx2 v[2:3], v4, s[44:47], 0 offen sc1
    s_waitcnt vmcnt(0)
    v_readfirstlane_b32 s34, v2
    v_readfirstlane_b32 s35, v3
    s_add_u32 s33, s33, 1
    s_cmp_ge_u32 s33, 262144
    s_cbranch_scc1 Lng1_d
    s_cmp_eq_u32 s34, 0
    s_cbranch_scc0 Lng1_d
    s_sleep 2
    s_branch Lng1
    Lng1_d:
    s_lshr_b32 s33, s34, 28
    s_lshl_b32 s97, s35, 4
    s_or_b32 s97, s97, s33
    s_lshl_b32 s96, s34, 4

    s_branch gated_mix__ssm_conv_h3__dense_activation_gelu__prompt_kernel_gotn2
    gated_mix__ssm_conv_h3__dense_activation_gelu__prompt_kernel_gotn:
    s_lshr_b32 s33, s34, 28
    s_lshl_b32 s97, s35, 4
    s_or_b32 s97, s97, s33
    s_lshl_b32 s96, s34, 4
    gated_mix__ssm_conv_h3__dense_activation_gelu__prompt_kernel_gotn2:

    v_mov_b32 v2, s96
    v_mov_b32 v3, s97
    v_mov_b32 v4, 163520
    ds_write_b64 v4, v[2:3]

    s_getreg_b32 s3, hwreg(HW_REG_XCC_ID, 0, 4)
    s_and_b32 s3, s3, 7
    s_add_u32 s3, s3, 1
    s_lshl_b32 s34, s16, 4
    s_add_u32 s34, s34, s17
    s_add_u32 s34, s34, 656

    s_or_b32 s33, s96, s3
    v_mov_b32 v2, s33
    v_mov_b32 v3, s97
    s_lshl_b32 s33, s34, 6
    v_mov_b32 v4, s33
    s_mov_b64 s[30:31], exec
    s_mov_b64 exec, 1
    buffer_store_dwordx2 v[2:3], v4, s[92:95], 0 offen sc1
    s_mov_b64 exec, s[30:31]

gated_mix__ssm_conv_h3__dense_activation_gelu__prompt_kernel_nopf:
    ds_read_b64_tr_b16 v[56:57], v31 offset:0
    ds_read_b64_tr_b16 v[58:59], v31 offset:512
    ds_read_b64_tr_b16 v[60:61], v31 offset:2048
    ds_read_b64_tr_b16 v[62:63], v31 offset:2560
    ds_read_b64_tr_b16 v[64:65], v31 offset:4096
    ds_read_b64_tr_b16 v[66:67], v31 offset:4608
    ds_read_b64_tr_b16 v[68:69], v31 offset:6144
    ds_read_b64_tr_b16 v[70:71], v31 offset:6656
    s_waitcnt lgkmcnt(6)
    v_mfma_f32_32x32x16_bf16 v[80:95], v[56:59], v[208:211], v[80:95]
    ds_read_b64_tr_b16 v[72:73], v31 offset:8192
    ds_read_b64_tr_b16 v[74:75], v31 offset:8704
    s_add_u32 s8, s8, 128
    s_addc_u32 s9, s9, 0
    s_waitcnt lgkmcnt(6)
    v_mfma_f32_32x32x16_bf16 v[80:95], v[60:63], v[212:215], v[80:95]
    ds_read_b64_tr_b16 v[76:77], v31 offset:10240
    ds_read_b64_tr_b16 v[78:79], v31 offset:10752
    s_add_u32 m0, s22, 0
    s_nop 0
    buffer_load_dwordx4 v34, s[8:11], s80 offen lds
    v_add_u32 v37, 256, v37
    ds_read_b128 v[8:11], v37 offset:0
    s_waitcnt lgkmcnt(7)
    v_mfma_f32_32x32x16_bf16 v[80:95], v[64:67], v[216:219], v[80:95]
    ds_read_b64_tr_b16 v[56:57], v31 offset:12288
    ds_read_b64_tr_b16 v[58:59], v31 offset:12800
    ds_read_b128 v[12:15], v37 offset:32
    s_waitcnt lgkmcnt(8)
    v_mfma_f32_32x32x16_bf16 v[80:95], v[68:71], v[220:223], v[80:95]
    ds_read_b64_tr_b16 v[60:61], v31 offset:14336
    ds_read_b64_tr_b16 v[62:63], v31 offset:14848
    s_add_u32 m0, s22, 1024
    s_nop 0
    buffer_load_dwordx4 v34, s[8:11], s81 offen lds
    ds_read_b128 v[16:19], v37 offset:64
    s_waitcnt lgkmcnt(9)
    v_mfma_f32_32x32x16_bf16 v[80:95], v[72:75], v[224:227], v[80:95]
    ds_read_b64_tr_b16 v[64:65], v31 offset:16384
    ds_read_b64_tr_b16 v[66:67], v31 offset:16896
    ds_read_b128 v[20:23], v37 offset:96
    s_waitcnt lgkmcnt(10)
    v_mfma_f32_32x32x16_bf16 v[80:95], v[76:79], v[228:231], v[80:95]
    ds_read_b64_tr_b16 v[68:69], v31 offset:18432
    ds_read_b64_tr_b16 v[70:71], v31 offset:18944
    s_add_u32 m0, s22, 2048
    s_nop 0
    buffer_load_dwordx4 v34, s[8:11], s82 offen lds
    s_waitcnt lgkmcnt(9)
    v_mfma_f32_32x32x16_bf16 v[80:95], v[56:59], v[232:235], v[80:95]
    ds_read_b64_tr_b16 v[72:73], v31 offset:20480
    ds_read_b64_tr_b16 v[74:75], v31 offset:20992
    s_waitcnt lgkmcnt(8)
    v_mfma_f32_32x32x16_bf16 v[80:95], v[60:63], v[236:239], v[80:95]
    ds_read_b64_tr_b16 v[76:77], v31 offset:22528
    ds_read_b64_tr_b16 v[78:79], v31 offset:23040
    s_add_u32 m0, s22, 24576
    s_nop 0
    buffer_load_dwordx4 v34, s[8:11], s83 offen lds
    s_waitcnt lgkmcnt(7)
    v_mfma_f32_32x32x16_bf16 v[80:95], v[64:67], v[240:243], v[80:95]
    ds_read_b64_tr_b16 v[56:57], v31 offset:24576
    ds_read_b64_tr_b16 v[58:59], v31 offset:25088
    s_waitcnt lgkmcnt(6)
    v_mfma_f32_32x32x16_bf16 v[80:95], v[68:71], v[244:247], v[80:95]
    ds_read_b64_tr_b16 v[60:61], v31 offset:26624
    ds_read_b64_tr_b16 v[62:63], v31 offset:27136
    s_add_u32 m0, s22, 25600
    s_nop 0
    buffer_load_dwordx4 v34, s[8:11], s84 offen lds
    s_waitcnt lgkmcnt(6)
    v_mfma_f32_32x32x16_bf16 v[80:95], v[72:75], v[248:251], v[80:95]
    ds_read_b64_tr_b16 v[64:65], v31 offset:28672
    ds_read_b64_tr_b16 v[66:67], v31 offset:29184
    s_waitcnt lgkmcnt(6)
    v_mfma_f32_32x32x16_bf16 v[80:95], v[76:79], v[252:255], v[80:95]
    ds_read_b64_tr_b16 v[68:69], v31 offset:30720
    ds_read_b64_tr_b16 v[70:71], v31 offset:31232
    s_add_u32 m0, s22, 26624
    s_nop 0
    buffer_load_dwordx4 v34, s[8:11], s85 offen lds
    s_waitcnt lgkmcnt(0)
    s_and_b32 s33, s17, 3
    s_cmp_eq_u32 s33, 3
    s_cselect_b32 s34, 32, 72
    s_load_dwordx2 s[60:61], s[0:1], s34
    s_cbranch_scc1 gated_mix__ssm_conv_h3__dense_activation_gelu__prompt_kernel_warm_c
    v_mul_u32_u24 v2, 21846, v1
    v_lshrrev_b32 v2, 16, v2
    v_mul_u32_u24 v3, 3, v2
    v_sub_u32 v3, v1, v3
    s_mul_i32 s34, s24, 1152
    s_and_b32 s35, s16, 7
    s_mul_i32 s35, s35, 144
    s_add_u32 s34, s34, s35
    s_mul_i32 s35, s98, 18
    s_add_u32 s34, s34, s35
    v_add_u32 v2, s34, v2
    s_movk_i32 s35, 1152
    v_mul_lo_u32 v2, v2, s35
    v_lshl_add_u32 v2, v3, 7, v2
    s_mul_i32 s33, s33, 384
    v_add_u32 v2, s33, v2
    v_min_u32 v2, 5308412, v2
    s_mov_b32 s66, 5308416
    s_branch gated_mix__ssm_conv_h3__dense_activation_gelu__prompt_kernel_warm_e
        gated_mix__ssm_conv_h3__dense_activation_gelu__prompt_kernel_warm_c:
    s_lshl_b32 s34, s16, 2
    s_add_u32 s34, s34, s24
    s_mul_i32 s34, s34, 36864
    s_mul_i32 s35, s98, 4608
    s_add_u32 s34, s34, s35
    v_min_u32 v2, 35, v1
    v_lshlrev_b32 v2, 7, v2
    v_add_u32 v2, s34, v2
    s_mov_b32 s66, 2359296
        gated_mix__ssm_conv_h3__dense_activation_gelu__prompt_kernel_warm_e:
    s_waitcnt lgkmcnt(0)
    s_mov_b32 s64, s60
    s_mov_b32 s65, s61
    s_mov_b32 s67, 0x00020000
    v_mov_b32 v39, v2

    s_lshr_b32 s36, s98, 2
    s_add_u32 s36, s36, 2
    s_cmp_eq_u32 s98, 7
    s_cselect_b32 s37, 2, 99
    s_cselect_b32 s39, 1, 99
    s_lshr_b32 s38, s98, 1
    s_cmp_eq_u32 s38, 2
    s_cselect_b32 s38, 1, 99
    s_cmp_eq_u32 s19, 1
    s_cbranch_scc0 gated_mix__ssm_conv_h3__dense_activation_gelu__prompt_kernel_dumT
    s_mov_b32 s33, 4096
    buffer_store_dwordx4 v[40:43], v52, s[12:15], s33 offen sc1
    buffer_store_dwordx4 v[44:47], v53, s[12:15], s33 offen sc1
    s_branch gated_mix__ssm_conv_h3__dense_activation_gelu__prompt_kernel_dumTe
    gated_mix__ssm_conv_h3__dense_activation_gelu__prompt_kernel_dumT:
    buffer_store_dword v36, v36, s[12:15], s32 offen
    buffer_store_dword v36, v36, s[12:15], s32 offen
    gated_mix__ssm_conv_h3__dense_activation_gelu__prompt_kernel_dumTe:

    s_mov_b32 s25, 1
    s_add_u32 s27, s27, 16384
    s_branch gated_mix__ssm_conv_h3__dense_activation_gelu__prompt_kernel_oddentry
.p2align 6
gated_mix__ssm_conv_h3__dense_activation_gelu__prompt_kernel_loop:
    s_waitcnt vmcnt(11)
    s_barrier
    s_waitcnt lgkmcnt(6)
    v_mfma_f32_32x32x16_bf16 v[80:95], v[56:59], v[112:115], v[8:23]
    s_cmp_eq_u32 s25, s36
    s_cbranch_scc1 gated_mix__ssm_conv_h3__dense_activation_gelu__prompt_kernel_oolw0
gated_mix__ssm_conv_h3__dense_activation_gelu__prompt_kernel_oolw0r:
    s_cmp_eq_u32 s25, s37
    s_cbranch_scc1 gated_mix__ssm_conv_h3__dense_activation_gelu__prompt_kernel_ool0
gated_mix__ssm_conv_h3__dense_activation_gelu__prompt_kernel_ool0r:
    ds_read_b64_tr_b16 v[72:73], v30 offset:8192
    ds_read_b64_tr_b16 v[74:75], v30 offset:8704
    buffer_store_dwordx4 v[40:43], v36, s[12:15], s26 offen
    s_waitcnt lgkmcnt(6)
    v_mfma_f32_32x32x16_bf16 v[80:95], v[60:63], v[116:119], v[80:95]
    s_add_u32 m0, s22, 122880
    ds_read_b64_tr_b16 v[76:77], v30 offset:10240
    ds_read_b64_tr_b16 v[78:79], v30 offset:10752
    buffer_load_dwordx4 v34, s[8:11], s86 offen lds
    v_mul_f32 v48, v96, v96
    v_mul_f32 v49, v97, v97
    v_fmaak_f32 v48, v48, v38, 0xc0135761
    s_waitcnt lgkmcnt(6)
    v_mfma_f32_32x32x16_bf16 v[80:95], v[64:67], v[120:123], v[80:95]
    ds_read_b64_tr_b16 v[56:57], v30 offset:12288
    ds_read_b64_tr_b16 v[58:59], v30 offset:12800
    v_fmaak_f32 v49, v49, v38, 0xc0135761
    v_mul_f32 v48, v48, v96
    v_mul_f32 v49, v49, v97
    v_exp_f32 v48, v48
    s_waitcnt lgkmcnt(6)
    v_mfma_f32_32x32x16_bf16 v[80:95], v[68:71], v[124:127], v[80:95]
    ds_read_b64_tr_b16 v[60:61], v30 offset:14336
    ds_read_b64_tr_b16 v[62:63], v30 offset:14848
    v_exp_f32 v49, v49
    v_mul_f32 v50, v98, v98
    v_add_f32 v48, 1.0, v48
    buffer_store_dwordx4 v[44:47], v36, s[12:15], s26 offen offset:1024
    s_waitcnt lgkmcnt(6)
    v_mfma_f32_32x32x16_bf16 v[80:95], v[72:75], v[128:131], v[80:95]
    ds_read_b64_tr_b16 v[64:65], v30 offset:16384
    ds_read_b64_tr_b16 v[66:67], v30 offset:16896
    v_mul_f32 v51, v99, v99
    v_add_f32 v49, 1.0, v49
    v_fmaak_f32 v50, v50, v38, 0xc0135761
    v_rcp_f32 v48, v48
    s_waitcnt lgkmcnt(6)
    v_mfma_f32_32x32x16_bf16 v[80:95], v[76:79], v[132:135], v[80:95]
    s_add_u32 m0, s22, 123904
    ds_read_b64_tr_b16 v[68:69], v30 offset:18432
    ds_read_b64_tr_b16 v[70:71], v30 offset:18944
    buffer_load_dwordx4 v34, s[8:11], s87 offen lds
    v_fmaak_f32 v51, v51, v38, 0xc0135761
    v_rcp_f32 v49, v49
    v_mul_f32 v50, v50, v98
    s_waitcnt lgkmcnt(6)
    v_mfma_f32_32x32x16_bf16 v[80:95], v[56:59], v[136:139], v[80:95]
    ds_read_b64_tr_b16 v[72:73], v30 offset:20480
    ds_read_b64_tr_b16 v[74:75], v30 offset:20992
    v_mul_f32 v96, v96, v48
    v_mul_f32 v51, v51, v99
    v_mul_f32 v97, v97, v49
    v_exp_f32 v50, v50
    s_waitcnt lgkmcnt(6)
    v_mfma_f32_32x32x16_bf16 v[80:95], v[60:63], v[140:143], v[80:95]
    ds_read_b64_tr_b16 v[76:77], v30 offset:22528
    ds_read_b64_tr_b16 v[78:79], v30 offset:23040
    v_cvt_pk_bf16_f32 v40, v96, v97
    v_exp_f32 v51, v51
    v_mul_f32 v48, v100, v100
    v_add_f32 v50, 1.0, v50
    s_waitcnt lgkmcnt(6)
    v_mfma_f32_32x32x16_bf16 v[80:95], v[64:67], v[144:147], v[80:95]
    ds_read_b64_tr_b16 v[56:57], v30 offset:24576
    ds_read_b64_tr_b16 v[58:59], v30 offset:25088
    v_mul_f32 v49, v101, v101
    v_add_f32 v51, 1.0, v51
    v_fmaak_f32 v48, v48, v38, 0xc0135761
    v_add_u32 v37, 256, v37
    s_waitcnt lgkmcnt(6)
    v_mfma_f32_32x32x16_bf16 v[80:95], v[68:71], v[148:151], v[80:95]
    s_add_u32 m0, s22, 124928
    ds_read_b64_tr_b16 v[60:61], v30 offset:26624
    ds_read_b64_tr_b16 v[62:63], v30 offset:27136
    buffer_load_dwordx4 v34, s[8:11], s88 offen lds
    v_rcp_f32 v50, v50
    v_fmaak_f32 v49, v49, v38, 0xc0135761
    ds_read_b128 v[8:11], v37 offset:0
    s_waitcnt lgkmcnt(7)
    v_mfma_f32_32x32x16_bf16 v[80:95], v[72:75], v[152:155], v[80:95]
    ds_read_b64_tr_b16 v[64:65], v30 offset:28672
    ds_read_b64_tr_b16 v[66:67], v30 offset:29184
    s_cmp_eq_u32 s25, 2
    s_cselect_b32 s29, s50, 128
    s_cselect_b32 s30, s51, 0
    s_add_u32 s8, s8, s29
    s_addc_u32 s9, s9, s30
    v_rcp_f32 v51, v51
    v_mul_f32 v48, v48, v100
    v_mul_f32 v98, v98, v50
    v_mul_f32 v49, v49, v101
    v_mul_f32 v99, v99, v51
    ds_read_b128 v[12:15], v37 offset:32
    s_waitcnt lgkmcnt(8)
    v_mfma_f32_32x32x16_bf16 v[80:95], v[76:79], v[156:159], v[80:95]
    s_waitcnt vmcnt(11)
    s_barrier
    s_waitcnt lgkmcnt(6)
    v_mfma_f32_32x32x16_bf16 v[80:95], v[56:59], v[160:163], v[80:95]
    ds_read_b64_tr_b16 v[68:69], v30 offset:30720
    ds_read_b64_tr_b16 v[70:71], v30 offset:31232
    ds_read_b64_tr_b16 v[72:73], v30 offset:32768
    ds_read_b64_tr_b16 v[74:75], v30 offset:33280
    v_exp_f32 v48, v48
    v_cvt_pk_bf16_f32 v41, v98, v99
    v_exp_f32 v49, v49
    v_mul_f32 v50, v102, v102
    s_waitcnt lgkmcnt(8)
    v_mfma_f32_32x32x16_bf16 v[80:95], v[60:63], v[164:167], v[80:95]
    s_add_u32 m0, s22, 0
    ds_read_b64_tr_b16 v[76:77], v30 offset:34816
    ds_read_b64_tr_b16 v[78:79], v30 offset:35328
    buffer_load_dwordx4 v34, s[8:11], s80 offen lds
    v_add_f32 v48, 1.0, v48
    v_mul_f32 v51, v103, v103
    v_add_f32 v49, 1.0, v49
    s_waitcnt lgkmcnt(7)
    v_mfma_f32_32x32x16_bf16 v[80:95], v[64:67], v[168:171], v[80:95]
    ds_read_b64_tr_b16 v[56:57], v30 offset:36864
    ds_read_b64_tr_b16 v[58:59], v30 offset:37376
    v_fmaak_f32 v50, v50, v38, 0xc0135761
    v_rcp_f32 v48, v48
    v_fmaak_f32 v51, v51, v38, 0xc0135761
    v_rcp_f32 v49, v49
    s_waitcnt lgkmcnt(6)
    v_mfma_f32_32x32x16_bf16 v[80:95], v[68:71], v[172:175], v[80:95]
    ds_read_b64_tr_b16 v[60:61], v30 offset:38912
    ds_read_b64_tr_b16 v[62:63], v30 offset:39424
    v_mul_f32 v50, v50, v102
    v_mul_f32 v100, v100, v48
    v_mul_f32 v51, v51, v103
    v_mul_f32 v101, v101, v49
    s_waitcnt lgkmcnt(6)
    v_mfma_f32_32x32x16_bf16 v[80:95], v[72:75], v[176:179], v[80:95]
    ds_read_b64_tr_b16 v[64:65], v30 offset:40960
    ds_read_b64_tr_b16 v[66:67], v30 offset:41472
    v_exp_f32 v50, v50
    v_cvt_pk_bf16_f32 v42, v100, v101
    v_exp_f32 v51, v51
    v_mul_f32 v48, v104, v104
    s_waitcnt lgkmcnt(6)
    v_mfma_f32_32x32x16_bf16 v[80:95], v[76:79], v[180:183], v[80:95]
    s_add_u32 m0, s22, 1024
    ds_read_b64_tr_b16 v[68:69], v30 offset:43008
    ds_read_b64_tr_b16 v[70:71], v30 offset:43520
    buffer_load_dwordx4 v34, s[8:11], s81 offen lds
    v_add_f32 v50, 1.0, v50
    v_mul_f32 v49, v105, v105
    v_add_f32 v51, 1.0, v51
    s_waitcnt lgkmcnt(6)
    v_mfma_f32_32x32x16_bf16 v[80:95], v[56:59], v[184:187], v[80:95]
    ds_read_b64_tr_b16 v[72:73], v30 offset:45056
    ds_read_b64_tr_b16 v[74:75], v30 offset:45568
    v_fmaak_f32 v48, v48, v38, 0xc0135761
    v_rcp_f32 v50, v50
    v_fmaak_f32 v49, v49, v38, 0xc0135761
    s_mov_b32 s26, s27
    s_waitcnt lgkmcnt(6)
    v_mfma_f32_32x32x16_bf16 v[80:95], v[60:63], v[188:191], v[80:95]
    ds_read_b64_tr_b16 v[76:77], v30 offset:47104
    ds_read_b64_tr_b16 v[78:79], v30 offset:47616
    v_rcp_f32 v51, v51
    v_mul_f32 v48, v48, v104
    v_mul_f32 v102, v102, v50
    v_mul_f32 v49, v49, v105
    v_mul_f32 v103, v103, v51
    s_add_u32 s27, s27, 16384
    s_cmp_eq_u32 s25, 0
    s_cselect_b32 s26, s32, s26
    s_waitcnt lgkmcnt(6)
    v_mfma_f32_32x32x16_bf16 v[80:95], v[64:67], v[192:195], v[80:95]
    ds_read_b64_tr_b16 v[56:57], v31 offset:0
    ds_read_b64_tr_b16 v[58:59], v31 offset:512
    v_exp_f32 v48, v48
    v_cvt_pk_bf16_f32 v43, v102, v103
    v_exp_f32 v49, v49
    v_mul_f32 v50, v106, v106
    ds_read_b128 v[16:19], v37 offset:64
    s_waitcnt lgkmcnt(7)
    v_mfma_f32_32x32x16_bf16 v[80:95], v[68:71], v[196:199], v[80:95]
    s_add_u32 m0, s22, 2048
    ds_read_b64_tr_b16 v[60:61], v31 offset:2048
    ds_read_b64_tr_b16 v[62:63], v31 offset:2560
    buffer_load_dwordx4 v34, s[8:11], s82 offen lds
    v_add_f32 v48, 1.0, v48
    v_mul_f32 v51, v107, v107
    v_add_f32 v49, 1.0, v49
    ds_read_b128 v[20:23], v37 offset:96
    s_waitcnt lgkmcnt(8)
    v_mfma_f32_32x32x16_bf16 v[80:95], v[72:75], v[200:203], v[80:95]
    ds_read_b64_tr_b16 v[64:65], v31 offset:4096
    ds_read_b64_tr_b16 v[66:67], v31 offset:4608
    v_fmaak_f32 v50, v50, v38, 0xc0135761
    v_rcp_f32 v48, v48
    v_fmaak_f32 v51, v51, v38, 0xc0135761
    s_waitcnt lgkmcnt(8)
    v_mfma_f32_32x32x16_bf16 v[80:95], v[76:79], v[204:207], v[80:95]
    s_waitcnt vmcnt(11)
    s_barrier
    s_waitcnt lgkmcnt(6)
    v_mfma_f32_32x32x16_bf16 v[80:95], v[56:59], v[208:211], v[80:95]
    ds_read_b64_tr_b16 v[68:69], v31 offset:6144
    ds_read_b64_tr_b16 v[70:71], v31 offset:6656
    ds_read_b64_tr_b16 v[72:73], v31 offset:8192
    ds_read_b64_tr_b16 v[74:75], v31 offset:8704
    v_rcp_f32 v49, v49
    v_mul_f32 v50, v50, v106
    v_mul_f32 v104, v104, v48
    v_mul_f32 v51, v51, v107
    v_mul_f32 v105, v105, v49
    s_waitcnt lgkmcnt(7)
    v_mfma_f32_32x32x16_bf16 v[80:95], v[60:63], v[212:215], v[80:95]
    s_add_u32 m0, s22, 24576
    ds_read_b64_tr_b16 v[76:77], v31 offset:10240
    ds_read_b64_tr_b16 v[78:79], v31 offset:10752
    buffer_load_dwordx4 v34, s[8:11], s83 offen lds
    v_exp_f32 v50, v50
    v_cvt_pk_bf16_f32 v44, v104, v105
    s_waitcnt lgkmcnt(6)
    v_mfma_f32_32x32x16_bf16 v[80:95], v[64:67], v[216:219], v[80:95]
    ds_read_b64_tr_b16 v[56:57], v31 offset:12288
    ds_read_b64_tr_b16 v[58:59], v31 offset:12800
    v_exp_f32 v51, v51
    v_mul_f32 v48, v108, v108
    v_add_f32 v50, 1.0, v50
    v_mul_f32 v49, v109, v109
    v_add_f32 v51, 1.0, v51
    s_waitcnt lgkmcnt(6)
    v_mfma_f32_32x32x16_bf16 v[80:95], v[68:71], v[220:223], v[80:95]
    ds_read_b64_tr_b16 v[60:61], v31 offset:14336
    ds_read_b64_tr_b16 v[62:63], v31 offset:14848
    v_fmaak_f32 v48, v48, v38, 0xc0135761
    v_rcp_f32 v50, v50
    v_fmaak_f32 v49, v49, v38, 0xc0135761
    s_waitcnt lgkmcnt(6)
    v_mfma_f32_32x32x16_bf16 v[80:95], v[72:75], v[224:227], v[80:95]
    ds_read_b64_tr_b16 v[64:65], v31 offset:16384
    ds_read_b64_tr_b16 v[66:67], v31 offset:16896
    v_rcp_f32 v51, v51
    v_mul_f32 v48, v48, v108
    v_mul_f32 v106, v106, v50
    v_mul_f32 v49, v49, v109
    v_mul_f32 v107, v107, v51
    s_waitcnt lgkmcnt(6)
    v_mfma_f32_32x32x16_bf16 v[80:95], v[76:79], v[228:231], v[80:95]
    s_add_u32 m0, s22, 25600
    ds_read_b64_tr_b16 v[68:69], v31 offset:18432
    ds_read_b64_tr_b16 v[70:71], v31 offset:18944
    buffer_load_dwordx4 v34, s[8:11], s84 offen lds
    v_exp_f32 v48, v48
    v_cvt_pk_bf16_f32 v45, v106, v107
    s_waitcnt lgkmcnt(6)
    v_mfma_f32_32x32x16_bf16 v[80:95], v[56:59], v[232:235], v[80:95]
    ds_read_b64_tr_b16 v[72:73], v31 offset:20480
    ds_read_b64_tr_b16 v[74:75], v31 offset:20992
    v_exp_f32 v49, v49
    v_mul_f32 v50, v110, v110
    v_add_f32 v48, 1.0, v48
    v_mul_f32 v51, v111, v111
    v_add_f32 v49, 1.0, v49
    s_waitcnt lgkmcnt(6)
    v_mfma_f32_32x32x16_bf16 v[80:95], v[60:63], v[236:239], v[80:95]
    ds_read_b64_tr_b16 v[76:77], v31 offset:22528
    ds_read_b64_tr_b16 v[78:79], v31 offset:23040
    v_fmaak_f32 v50, v50, v38, 0xc0135761
    v_rcp_f32 v48, v48
    v_fmaak_f32 v51, v51, v38, 0xc0135761
    s_waitcnt lgkmcnt(6)
    v_mfma_f32_32x32x16_bf16 v[80:95], v[64:67], v[240:243], v[80:95]
    ds_read_b64_tr_b16 v[56:57], v31 offset:24576
    ds_read_b64_tr_b16 v[58:59], v31 offset:25088
    v_rcp_f32 v49, v49
    v_mul_f32 v50, v50, v110
    v_mul_f32 v108, v108, v48
    v_mul_f32 v51, v51, v111
    v_mul_f32 v109, v109, v49
    s_waitcnt lgkmcnt(6)
    v_mfma_f32_32x32x16_bf16 v[80:95], v[68:71], v[244:247], v[80:95]
    s_add_u32 m0, s22, 26624
    ds_read_b64_tr_b16 v[60:61], v31 offset:26624
    ds_read_b64_tr_b16 v[62:63], v31 offset:27136
    buffer_load_dwordx4 v34, s[8:11], s85 offen lds
    v_exp_f32 v50, v50
    v_cvt_pk_bf16_f32 v46, v108, v109
    s_waitcnt lgkmcnt(6)
    v_mfma_f32_32x32x16_bf16 v[80:95], v[72:75], v[248:251], v[80:95]
    ds_read_b64_tr_b16 v[64:65], v31 offset:28672
    ds_read_b64_tr_b16 v[66:67], v31 offset:29184
    v_exp_f32 v51, v51
    v_add_f32 v50, 1.0, v50
    v_add_f32 v51, 1.0, v51
    v_rcp_f32 v50, v50
    s_waitcnt lgkmcnt(6)
    v_mfma_f32_32x32x16_bf16 v[80:95], v[76:79], v[252:255], v[80:95]
    ds_read_b64_tr_b16 v[68:69], v31 offset:30720
    ds_read_b64_tr_b16 v[70:71], v31 offset:31232
    v_rcp_f32 v51, v51
    v_mul_f32 v110, v110, v50
    v_mul_f32 v111, v111, v51
    v_cvt_pk_bf16_f32 v47, v110, v111
    s_add_u32 s25, s25, 1
gated_mix__ssm_conv_h3__dense_activation_gelu__prompt_kernel_oddentry:
    s_waitcnt vmcnt(11)
    s_barrier
    s_waitcnt lgkmcnt(6)
    v_mfma_f32_32x32x16_bf16 v[96:111], v[56:59], v[112:115], v[8:23]
    s_cmp_eq_u32 s25, s36
    s_cbranch_scc1 gated_mix__ssm_conv_h3__dense_activation_gelu__prompt_kernel_oolw1
gated_mix__ssm_conv_h3__dense_activation_gelu__prompt_kernel_oolw1r:
    s_cmp_eq_u32 s25, s39
    s_cbranch_scc1 gated_mix__ssm_conv_h3__dense_activation_gelu__prompt_kernel_oolt
gated_mix__ssm_conv_h3__dense_activation_gelu__prompt_kernel_ooltr:
    ds_read_b64_tr_b16 v[72:73], v31 offset:32768
    ds_read_b64_tr_b16 v[74:75], v31 offset:33280
    s_cmp_eq_u32 s25, 1
    s_cbranch_scc1 gated_mix__ssm_conv_h3__dense_activation_gelu__prompt_kernel_o_ns0
    buffer_store_dwordx4 v[40:43], v36, s[12:15], s26 offen
gated_mix__ssm_conv_h3__dense_activation_gelu__prompt_kernel_o_ns0:
    s_waitcnt lgkmcnt(6)
    v_mfma_f32_32x32x16_bf16 v[96:111], v[60:63], v[116:119], v[96:111]
    s_add_u32 m0, s22, 49152
    ds_read_b64_tr_b16 v[76:77], v31 offset:34816
    ds_read_b64_tr_b16 v[78:79], v31 offset:35328
    buffer_load_dwordx4 v34, s[8:11], s86 offen lds
    v_mul_f32 v48, v80, v80
    v_mul_f32 v49, v81, v81
    v_fmaak_f32 v48, v48, v38, 0xc0135761
    s_waitcnt lgkmcnt(6)
    v_mfma_f32_32x32x16_bf16 v[96:111], v[64:67], v[120:123], v[96:111]
    ds_read_b64_tr_b16 v[56:57], v31 offset:36864
    ds_read_b64_tr_b16 v[58:59], v31 offset:37376
    v_fmaak_f32 v49, v49, v38, 0xc0135761
    v_mul_f32 v48, v48, v80
    v_mul_f32 v49, v49, v81
    v_exp_f32 v48, v48
    s_waitcnt lgkmcnt(6)
    v_mfma_f32_32x32x16_bf16 v[96:111], v[68:71], v[124:127], v[96:111]
    ds_read_b64_tr_b16 v[60:61], v31 offset:38912
    ds_read_b64_tr_b16 v[62:63], v31 offset:39424
    v_exp_f32 v49, v49
    v_mul_f32 v50, v82, v82
    v_add_f32 v48, 1.0, v48
    s_cmp_eq_u32 s25, 1
    s_cbranch_scc1 gated_mix__ssm_conv_h3__dense_activation_gelu__prompt_kernel_o_ns3
    buffer_store_dwordx4 v[44:47], v36, s[12:15], s26 offen offset:1024
gated_mix__ssm_conv_h3__dense_activation_gelu__prompt_kernel_o_ns3:
    s_waitcnt lgkmcnt(6)
    v_mfma_f32_32x32x16_bf16 v[96:111], v[72:75], v[128:131], v[96:111]
    ds_read_b64_tr_b16 v[64:65], v31 offset:40960
    ds_read_b64_tr_b16 v[66:67], v31 offset:41472
    v_mul_f32 v51, v83, v83
    v_add_f32 v49, 1.0, v49
    v_fmaak_f32 v50, v50, v38, 0xc0135761
    v_rcp_f32 v48, v48
    s_waitcnt lgkmcnt(6)
    v_mfma_f32_32x32x16_bf16 v[96:111], v[76:79], v[132:135], v[96:111]
    s_add_u32 m0, s22, 50176
    ds_read_b64_tr_b16 v[68:69], v31 offset:43008
    ds_read_b64_tr_b16 v[70:71], v31 offset:43520
    buffer_load_dwordx4 v34, s[8:11], s87 offen lds
    v_fmaak_f32 v51, v51, v38, 0xc0135761
    v_rcp_f32 v49, v49
    v_mul_f32 v50, v50, v82
    s_waitcnt lgkmcnt(6)
    v_mfma_f32_32x32x16_bf16 v[96:111], v[56:59], v[136:139], v[96:111]
    ds_read_b64_tr_b16 v[72:73], v31 offset:45056
    ds_read_b64_tr_b16 v[74:75], v31 offset:45568
    v_mul_f32 v80, v80, v48
    v_mul_f32 v51, v51, v83
    v_mul_f32 v81, v81, v49
    v_exp_f32 v50, v50
    s_waitcnt lgkmcnt(6)
    v_mfma_f32_32x32x16_bf16 v[96:111], v[60:63], v[140:143], v[96:111]
    ds_read_b64_tr_b16 v[76:77], v31 offset:47104
    ds_read_b64_tr_b16 v[78:79], v31 offset:47616
    v_cvt_pk_bf16_f32 v40, v80, v81
    v_exp_f32 v51, v51
    v_mul_f32 v48, v84, v84
    v_add_f32 v50, 1.0, v50
    s_cmp_eq_u32 s25, 3
    s_cselect_b32 s29, s48, 256
    s_waitcnt lgkmcnt(6)
    v_mfma_f32_32x32x16_bf16 v[96:111], v[64:67], v[144:147], v[96:111]
    ds_read_b64_tr_b16 v[56:57], v32 offset:0
    ds_read_b64_tr_b16 v[58:59], v32 offset:512
    v_mul_f32 v49, v85, v85
    v_add_f32 v51, 1.0, v51
    v_fmaak_f32 v48, v48, v38, 0xc0135761
    v_rcp_f32 v50, v50
    v_add_u32 v37, s29, v37
    s_waitcnt lgkmcnt(6)
    v_mfma_f32_32x32x16_bf16 v[96:111], v[68:71], v[148:151], v[96:111]
    s_add_u32 m0, s22, 51200
    ds_read_b64_tr_b16 v[60:61], v32 offset:2048
    ds_read_b64_tr_b16 v[62:63], v32 offset:2560
    buffer_load_dwordx4 v34, s[8:11], s88 offen lds
    v_fmaak_f32 v49, v49, v38, 0xc0135761
    v_rcp_f32 v51, v51
    ds_read_b128 v[8:11], v37 offset:0
    s_waitcnt lgkmcnt(7)
    v_mfma_f32_32x32x16_bf16 v[96:111], v[72:75], v[152:155], v[96:111]
    ds_read_b64_tr_b16 v[64:65], v32 offset:4096
    ds_read_b64_tr_b16 v[66:67], v32 offset:4608
    s_add_u32 s8, s8, 128
    s_addc_u32 s9, s9, 0
    v_mul_f32 v48, v48, v84
    v_mul_f32 v82, v82, v50
    v_mul_f32 v49, v49, v85
    v_mul_f32 v83, v83, v51
    ds_read_b128 v[12:15], v37 offset:32
    s_waitcnt lgkmcnt(8)
    v_mfma_f32_32x32x16_bf16 v[96:111], v[76:79], v[156:159], v[96:111]
    s_waitcnt vmcnt(11)
    s_barrier
    s_waitcnt lgkmcnt(6)
    v_mfma_f32_32x32x16_bf16 v[96:111], v[56:59], v[160:163], v[96:111]
    ds_read_b64_tr_b16 v[68:69], v32 offset:6144
    ds_read_b64_tr_b16 v[70:71], v32 offset:6656
    ds_read_b64_tr_b16 v[72:73], v32 offset:8192
    ds_read_b64_tr_b16 v[74:75], v32 offset:8704
    v_exp_f32 v48, v48
    v_cvt_pk_bf16_f32 v41, v82, v83
    v_exp_f32 v49, v49
    v_mul_f32 v50, v86, v86
    s_waitcnt lgkmcnt(8)
    v_mfma_f32_32x32x16_bf16 v[96:111], v[60:63], v[164:167], v[96:111]
    s_add_u32 m0, s22, 73728
    ds_read_b64_tr_b16 v[76:77], v32 offset:10240
    ds_read_b64_tr_b16 v[78:79], v32 offset:10752
    s_cmp_eq_u32 s25, 3
    s_cbranch_scc1 gated_mix__ssm_conv_h3__dense_activation_gelu__prompt_kernel_o_skip12_0
    buffer_load_dwordx4 v34, s[8:11], s80 offen lds
gated_mix__ssm_conv_h3__dense_activation_gelu__prompt_kernel_o_skip12_0:
    v_add_f32 v48, 1.0, v48
    v_mul_f32 v51, v87, v87
    v_add_f32 v49, 1.0, v49
    v_fmaak_f32 v50, v50, v38, 0xc0135761
    s_waitcnt lgkmcnt(7)
    v_mfma_f32_32x32x16_bf16 v[96:111], v[64:67], v[168:171], v[96:111]
    ds_read_b64_tr_b16 v[56:57], v32 offset:12288
    ds_read_b64_tr_b16 v[58:59], v32 offset:12800
    v_rcp_f32 v48, v48
    v_fmaak_f32 v51, v51, v38, 0xc0135761
    v_rcp_f32 v49, v49
    s_waitcnt lgkmcnt(6)
    v_mfma_f32_32x32x16_bf16 v[96:111], v[68:71], v[172:175], v[96:111]
    ds_read_b64_tr_b16 v[60:61], v32 offset:14336
    ds_read_b64_tr_b16 v[62:63], v32 offset:14848
    v_mul_f32 v50, v50, v86
    v_mul_f32 v84, v84, v48
    v_mul_f32 v51, v51, v87
    v_mul_f32 v85, v85, v49
    s_waitcnt lgkmcnt(6)
    v_mfma_f32_32x32x16_bf16 v[96:111], v[72:75], v[176:179], v[96:111]
    ds_read_b64_tr_b16 v[64:65], v32 offset:16384
    ds_read_b64_tr_b16 v[66:67], v32 offset:16896
    v_exp_f32 v50, v50
    v_cvt_pk_bf16_f32 v42, v84, v85
    v_exp_f32 v51, v51
    v_mul_f32 v48, v88, v88
    s_waitcnt lgkmcnt(6)
    v_mfma_f32_32x32x16_bf16 v[96:111], v[76:79], v[180:183], v[96:111]
    s_add_u32 m0, s22, 74752
    ds_read_b64_tr_b16 v[68:69], v32 offset:18432
    ds_read_b64_tr_b16 v[70:71], v32 offset:18944
    s_cmp_eq_u32 s25, 3
    s_cbranch_scc1 gated_mix__ssm_conv_h3__dense_activation_gelu__prompt_kernel_o_skip12_1
    buffer_load_dwordx4 v34, s[8:11], s81 offen lds
gated_mix__ssm_conv_h3__dense_activation_gelu__prompt_kernel_o_skip12_1:
    v_add_f32 v50, 1.0, v50
    v_mul_f32 v49, v89, v89
    v_add_f32 v51, 1.0, v51
    v_fmaak_f32 v48, v48, v38, 0xc0135761
    s_waitcnt lgkmcnt(6)
    v_mfma_f32_32x32x16_bf16 v[96:111], v[56:59], v[184:187], v[96:111]
    ds_read_b64_tr_b16 v[72:73], v32 offset:20480
    ds_read_b64_tr_b16 v[74:75], v32 offset:20992
    v_rcp_f32 v50, v50
    v_fmaak_f32 v49, v49, v38, 0xc0135761
    v_rcp_f32 v51, v51
    s_mov_b32 s26, s27
    s_waitcnt lgkmcnt(6)
    v_mfma_f32_32x32x16_bf16 v[96:111], v[60:63], v[188:191], v[96:111]
    ds_read_b64_tr_b16 v[76:77], v32 offset:22528
    ds_read_b64_tr_b16 v[78:79], v32 offset:23040
    v_mul_f32 v48, v48, v88
    v_mul_f32 v86, v86, v50
    v_mul_f32 v49, v49, v89
    v_mul_f32 v87, v87, v51
    v_exp_f32 v48, v48
    s_add_u32 s27, s27, 16384
    s_cmp_eq_u32 s25, 0
    s_cselect_b32 s26, s32, s26
    s_waitcnt lgkmcnt(6)
    v_mfma_f32_32x32x16_bf16 v[96:111], v[64:67], v[192:195], v[96:111]
    ds_read_b64_tr_b16 v[56:57], v32 offset:24576
    ds_read_b64_tr_b16 v[58:59], v32 offset:25088
    v_cvt_pk_bf16_f32 v43, v86, v87
    v_exp_f32 v49, v49
    v_mul_f32 v50, v90, v90
    v_add_f32 v48, 1.0, v48
    ds_read_b128 v[16:19], v37 offset:64
    s_waitcnt lgkmcnt(7)
    v_mfma_f32_32x32x16_bf16 v[96:111], v[68:71], v[196:199], v[96:111]
    s_add_u32 m0, s22, 75776
    ds_read_b64_tr_b16 v[60:61], v32 offset:26624
    ds_read_b64_tr_b16 v[62:63], v32 offset:27136
    s_cmp_eq_u32 s25, 3
    s_cbranch_scc1 gated_mix__ssm_conv_h3__dense_activation_gelu__prompt_kernel_o_skip12_2
    buffer_load_dwordx4 v34, s[8:11], s82 offen lds
gated_mix__ssm_conv_h3__dense_activation_gelu__prompt_kernel_o_skip12_2:
    v_mul_f32 v51, v91, v91
    v_add_f32 v49, 1.0, v49
    v_fmaak_f32 v50, v50, v38, 0xc0135761
    ds_read_b128 v[20:23], v37 offset:96
    s_waitcnt lgkmcnt(8)
    v_mfma_f32_32x32x16_bf16 v[96:111], v[72:75], v[200:203], v[96:111]
    ds_read_b64_tr_b16 v[64:65], v32 offset:28672
    ds_read_b64_tr_b16 v[66:67], v32 offset:29184
    v_rcp_f32 v48, v48
    v_fmaak_f32 v51, v51, v38, 0xc0135761
    v_rcp_f32 v49, v49
    s_waitcnt lgkmcnt(8)
    v_mfma_f32_32x32x16_bf16 v[96:111], v[76:79], v[204:207], v[96:111]
    s_cmp_eq_u32 s25, 3
    s_cbranch_scc1 gated_mix__ssm_conv_h3__dense_activation_gelu__prompt_kernel_o_w8
    s_waitcnt vmcnt(11)
gated_mix__ssm_conv_h3__dense_activation_gelu__prompt_kernel_o_w8d:
    s_barrier
    s_waitcnt lgkmcnt(6)
    v_mfma_f32_32x32x16_bf16 v[96:111], v[56:59], v[208:211], v[96:111]
    ds_read_b64_tr_b16 v[68:69], v32 offset:30720
    ds_read_b64_tr_b16 v[70:71], v32 offset:31232
    ds_read_b64_tr_b16 v[72:73], v32 offset:32768
    ds_read_b64_tr_b16 v[74:75], v32 offset:33280
    v_mul_f32 v50, v50, v90
    v_mul_f32 v88, v88, v48
    v_mul_f32 v51, v51, v91
    v_mul_f32 v89, v89, v49
    v_exp_f32 v50, v50
    s_waitcnt lgkmcnt(7)
    v_mfma_f32_32x32x16_bf16 v[96:111], v[60:63], v[212:215], v[96:111]
    s_add_u32 m0, s22, 98304
    ds_read_b64_tr_b16 v[76:77], v32 offset:34816
    ds_read_b64_tr_b16 v[78:79], v32 offset:35328
    s_cmp_eq_u32 s25, 3
    s_cbranch_scc1 gated_mix__ssm_conv_h3__dense_activation_gelu__prompt_kernel_o_skip24_0
    buffer_load_dwordx4 v34, s[8:11], s83 offen lds
gated_mix__ssm_conv_h3__dense_activation_gelu__prompt_kernel_o_skip24_0:
    v_cvt_pk_bf16_f32 v44, v88, v89
    v_exp_f32 v51, v51
    s_waitcnt lgkmcnt(6)
    v_mfma_f32_32x32x16_bf16 v[96:111], v[64:67], v[216:219], v[96:111]
    ds_read_b64_tr_b16 v[56:57], v32 offset:36864
    ds_read_b64_tr_b16 v[58:59], v32 offset:37376
    v_mul_f32 v48, v92, v92
    v_add_f32 v50, 1.0, v50
    v_mul_f32 v49, v93, v93
    v_add_f32 v51, 1.0, v51
    v_fmaak_f32 v48, v48, v38, 0xc0135761
    s_waitcnt lgkmcnt(6)
    v_mfma_f32_32x32x16_bf16 v[96:111], v[68:71], v[220:223], v[96:111]
    ds_read_b64_tr_b16 v[60:61], v32 offset:38912
    ds_read_b64_tr_b16 v[62:63], v32 offset:39424
    v_rcp_f32 v50, v50
    v_fmaak_f32 v49, v49, v38, 0xc0135761
    v_rcp_f32 v51, v51
    v_mul_f32 v48, v48, v92
    s_waitcnt lgkmcnt(6)
    v_mfma_f32_32x32x16_bf16 v[96:111], v[72:75], v[224:227], v[96:111]
    ds_read_b64_tr_b16 v[64:65], v32 offset:40960
    ds_read_b64_tr_b16 v[66:67], v32 offset:41472
    v_mul_f32 v90, v90, v50
    v_mul_f32 v49, v49, v93
    v_mul_f32 v91, v91, v51
    v_exp_f32 v48, v48
    s_waitcnt lgkmcnt(6)
    v_mfma_f32_32x32x16_bf16 v[96:111], v[76:79], v[228:231], v[96:111]
    s_add_u32 m0, s22, 99328
    ds_read_b64_tr_b16 v[68:69], v32 offset:43008
    ds_read_b64_tr_b16 v[70:71], v32 offset:43520
    s_cmp_eq_u32 s25, 3
    s_cbranch_scc1 gated_mix__ssm_conv_h3__dense_activation_gelu__prompt_kernel_o_skip24_1
    buffer_load_dwordx4 v34, s[8:11], s84 offen lds
gated_mix__ssm_conv_h3__dense_activation_gelu__prompt_kernel_o_skip24_1:
    v_cvt_pk_bf16_f32 v45, v90, v91
    v_exp_f32 v49, v49
    s_waitcnt lgkmcnt(6)
    v_mfma_f32_32x32x16_bf16 v[96:111], v[56:59], v[232:235], v[96:111]
    ds_read_b64_tr_b16 v[72:73], v32 offset:45056
    ds_read_b64_tr_b16 v[74:75], v32 offset:45568
    v_mul_f32 v50, v94, v94
    v_add_f32 v48, 1.0, v48
    v_mul_f32 v51, v95, v95
    v_add_f32 v49, 1.0, v49
    s_cmp_eq_u32 s25, 3
    s_cselect_b32 s29, s49, 0
    v_xor_b32 v30, s29, v30
    v_xor_b32 v31, s29, v31
    s_waitcnt lgkmcnt(6)
    v_mfma_f32_32x32x16_bf16 v[96:111], v[60:63], v[236:239], v[96:111]
    ds_read_b64_tr_b16 v[76:77], v32 offset:47104
    ds_read_b64_tr_b16 v[78:79], v32 offset:47616
    v_fmaak_f32 v50, v50, v38, 0xc0135761
    v_rcp_f32 v48, v48
    v_fmaak_f32 v51, v51, v38, 0xc0135761
    s_waitcnt lgkmcnt(6)
    v_mfma_f32_32x32x16_bf16 v[96:111], v[64:67], v[240:243], v[96:111]
    ds_read_b64_tr_b16 v[56:57], v30 offset:0
    ds_read_b64_tr_b16 v[58:59], v30 offset:512
    v_rcp_f32 v49, v49
    v_mul_f32 v50, v50, v94
    v_mul_f32 v92, v92, v48
    v_mul_f32 v51, v51, v95
    v_mul_f32 v93, v93, v49
    s_waitcnt lgkmcnt(6)
    v_mfma_f32_32x32x16_bf16 v[96:111], v[68:71], v[244:247], v[96:111]
    s_add_u32 m0, s22, 100352
    ds_read_b64_tr_b16 v[60:61], v30 offset:2048
    ds_read_b64_tr_b16 v[62:63], v30 offset:2560
    s_cmp_eq_u32 s25, 3
    s_cbranch_scc1 gated_mix__ssm_conv_h3__dense_activation_gelu__prompt_kernel_o_skip24_2
    buffer_load_dwordx4 v34, s[8:11], s85 offen lds
gated_mix__ssm_conv_h3__dense_activation_gelu__prompt_kernel_o_skip24_2:
    v_exp_f32 v50, v50
    v_cvt_pk_bf16_f32 v46, v92, v93
    s_waitcnt lgkmcnt(6)
    v_mfma_f32_32x32x16_bf16 v[96:111], v[72:75], v[248:251], v[96:111]
    ds_read_b64_tr_b16 v[64:65], v30 offset:4096
    ds_read_b64_tr_b16 v[66:67], v30 offset:4608
    v_exp_f32 v51, v51
    v_add_f32 v50, 1.0, v50
    v_add_f32 v51, 1.0, v51
    v_rcp_f32 v50, v50
    s_waitcnt lgkmcnt(6)
    v_mfma_f32_32x32x16_bf16 v[96:111], v[76:79], v[252:255], v[96:111]
    ds_read_b64_tr_b16 v[68:69], v30 offset:6144
    ds_read_b64_tr_b16 v[70:71], v30 offset:6656
    v_rcp_f32 v51, v51
    v_mul_f32 v94, v94, v50
    v_mul_f32 v95, v95, v51
    v_cvt_pk_bf16_f32 v47, v94, v95
    s_add_u32 s25, s25, 1
    s_cmp_lt_u32 s25, 4
    s_cbranch_scc1 gated_mix__ssm_conv_h3__dense_activation_gelu__prompt_kernel_loop
    s_branch gated_mix__ssm_conv_h3__dense_activation_gelu__prompt_kernel_oolx
gated_mix__ssm_conv_h3__dense_activation_gelu__prompt_kernel_oolw0:
    buffer_load_dword v29, v39, s[64:67], 0 offen
    s_branch gated_mix__ssm_conv_h3__dense_activation_gelu__prompt_kernel_oolw0r
gated_mix__ssm_conv_h3__dense_activation_gelu__prompt_kernel_ool0:
    s_lshl_b32 s34, s16, 4
    s_and_b32 s33, s17, 12
    s_add_u32 s34, s34, s33
    s_add_u32 s34, s34, 656
    v_add_u32 v2, s34, v1
    v_min_u32 v2, 1679, v2
    v_lshlrev_b32 v2, 6, v2
    buffer_load_dwordx2 v[54:55], v2, s[92:95], 0 offen sc1
    s_cmp_lg_u32 s19, 1
    s_cbranch_scc1 gated_mix__ssm_conv_h3__dense_activation_gelu__prompt_kernel_ool0r
    s_mul_i32 s34, s16, 9
    s_add_u32 s34, s34, s23
    s_add_u32 s34, s34, 0

    s_or_b32 s33, s96, 1
    v_mov_b32 v2, s33
    v_mov_b32 v3, s97
    s_lshl_b32 s33, s34, 6
    v_mov_b32 v4, s33
    s_mov_b64 s[30:31], exec
    s_mov_b64 exec, 1
    buffer_store_dwordx2 v[2:3], v4, s[92:95], 0 offen sc1
    s_mov_b64 exec, s[30:31]

    s_branch gated_mix__ssm_conv_h3__dense_activation_gelu__prompt_kernel_ool0r
gated_mix__ssm_conv_h3__dense_activation_gelu__prompt_kernel_oolw1:
    buffer_load_dword v29, v39, s[64:67], 0 offen
    s_branch gated_mix__ssm_conv_h3__dense_activation_gelu__prompt_kernel_oolw1r
gated_mix__ssm_conv_h3__dense_activation_gelu__prompt_kernel_oolt:
    s_mul_i32 s33, s16, 144
    s_mul_i32 s34, s17, 9
    s_add_u32 s33, s33, s34
    v_min_u32 v2, 8, v1
    v_add_u32 v2, s33, v2
    v_lshlrev_b32 v2, 13, v2
    v_add_u32 v2, 5242880, v2
    v_mov_b32 v3, 0
    v_cmp_eq_u32 vcc, 9, v1
    s_nop 1
    v_cndmask_b32 v2, v2, v3, vcc
    v_mov_b32 v3, 0x241000
    v_cmp_eq_u32 vcc, 10, v1
    s_nop 1
    v_cndmask_b32 v2, v2, v3, vcc
    v_mov_b32 v3, 4816896
    v_cmp_eq_u32 vcc, 11, v1
    s_nop 1
    v_cndmask_b32 v2, v2, v3, vcc
    v_subrev_u32 v3, 12, v1
    v_and_b32 v3, 3, v3
    v_lshlrev_b32 v4, 4, v3
    v_add_u32 v4, s16, v4
    v_lshl_add_u32 v4, v4, 2, v3
    v_mul_u32_u24 v4, 36864, v4
    v_add_u32 v4, 24117248, v4
    v_cmp_le_u32 vcc, 12, v1
    s_nop 1
    v_cndmask_b32 v2, v2, v4, vcc
    s_mov_b32 s44, s42
    s_mov_b32 s45, s43
    s_mov_b32 s46, 42991616
    s_mov_b32 s47, 0x00020000
    s_mov_b32 exec_hi, 0
    s_mov_b32 exec_lo, 0xffff
    buffer_load_dword v29, v2, s[44:47], 0 offen sc1
    s_mov_b64 exec, -1

    s_mov_b32 s44, s52
    s_mov_b32 s45, s53
    s_mov_b32 s46, 5308416
    s_mov_b32 s47, 0x00020000
    v_and_b32 v2, 15, v1
    s_mov_b32 s33, 331776
    v_mul_lo_u32 v2, v2, s33
    buffer_load_dword v29, v2, s[44:47], 0 offen
    s_mov_b32 s44, s54
    s_mov_b32 s45, s55
    s_mov_b32 s46, 2359296
    s_mov_b32 s47, 0x00020000
    s_mul_i32 s33, s16, 147456
    v_mov_b32 v2, s33
    buffer_load_dword v29, v2, s[44:47], 0 offen
    s_mov_b32 s44, s56
    s_mov_b32 s45, s57
    s_mov_b32 s46, 2359296
    s_mov_b32 s47, 0x00020000
    v_and_b32 v2, 15, v1
    s_mov_b32 s33, 147456
    v_mul_lo_u32 v2, v2, s33
    buffer_load_dword v29, v2, s[44:47], 0 offen
    s_branch gated_mix__ssm_conv_h3__dense_activation_gelu__prompt_kernel_ooltr
gated_mix__ssm_conv_h3__dense_activation_gelu__prompt_kernel_o_w8:
    s_waitcnt vmcnt(8)
    s_branch gated_mix__ssm_conv_h3__dense_activation_gelu__prompt_kernel_o_w8d
gated_mix__ssm_conv_h3__dense_activation_gelu__prompt_kernel_oolx:
    s_waitcnt vmcnt(2)
    s_barrier
    s_cmp_lg_u32 s98, 7
    s_cbranch_scc1 gated_mix__ssm_conv_h3__dense_activation_gelu__prompt_kernel_nof2
    v_subrev_u32 v4, s96, v54
    v_cmp_eq_u32 vcc, s3, v4
    v_cmp_eq_u32 s[34:35], s97, v55
    s_and_b64 vcc, vcc, s[34:35]
    s_and_b32 s33, vcc_lo, 15
    s_cmp_eq_u32 s33, 15
    s_cselect_b32 s77, 1, 0
    v_mov_b32 v2, 81608
    v_mov_b32 v3, s77
    ds_write_b32 v2, v3
    s_cmp_eq_u32 s77, 1
    s_cbranch_scc1 gated_mix__ssm_conv_h3__dense_activation_gelu__prompt_kernel_sameH
    buffer_wbl2 sc1
    s_waitcnt vmcnt(0)
gated_mix__ssm_conv_h3__dense_activation_gelu__prompt_kernel_sameH:

    s_lshl_b32 s34, s16, 4
    s_add_u32 s34, s34, s17
    s_add_u32 s34, s34, 208
    s_or_b32 s33, s96, 2
    v_mov_b32 v2, s33
    v_mov_b32 v3, s97
    s_lshl_b32 s33, s34, 6
    v_mov_b32 v4, s33
    s_mov_b64 s[30:31], exec
    s_mov_b64 exec, 1
    buffer_store_dwordx2 v[2:3], v4, s[92:95], 0 offen sc1
    s_mov_b64 exec, s[30:31]

    s_waitcnt lgkmcnt(0)
gated_mix__ssm_conv_h3__dense_activation_gelu__prompt_kernel_nof2:
    s_cmp_lg_u32 s98, 7
    s_cbranch_scc1 gated_mix__ssm_conv_h3__dense_activation_gelu__prompt_kernel_nocz
    v_mov_b32 v2, 81600
    v_mov_b32 v4, 0
    v_mov_b32 v5, 0
    ds_write_b64 v2, v[4:5]
    ds_write_b64 v2, v[4:5] offset:16
    ds_write_b64 v2, v[4:5] offset:24
    s_waitcnt lgkmcnt(0)
    gated_mix__ssm_conv_h3__dense_activation_gelu__prompt_kernel_nocz:

    s_lshl_b32 s21, s16, 4
    s_add_u32 s21, s21, s17
    s_add_u32 s21, s21, 208
    s_cmp_ge_u32 s98, 4
    s_cbranch_scc1 gated_mix__ssm_conv_h3__dense_activation_gelu__prompt_kernel_tailB

    s_waitcnt lgkmcnt(6)
    v_mfma_f32_32x32x16_bf16 v[80:95], v[56:59], v[112:115], v[8:23]
    ds_read_b64_tr_b16 v[72:73], v30 offset:8192
    ds_read_b64_tr_b16 v[74:75], v30 offset:8704
    buffer_store_dwordx4 v[40:43], v36, s[12:15], s26 offen
    s_waitcnt lgkmcnt(6)
    v_mfma_f32_32x32x16_bf16 v[80:95], v[60:63], v[116:119], v[80:95]
    ds_read_b64_tr_b16 v[76:77], v30 offset:10240
    ds_read_b64_tr_b16 v[78:79], v30 offset:10752
    v_mul_f32 v48, v96, v96
    v_mul_f32 v49, v97, v97
    v_fmaak_f32 v48, v48, v38, 0xc0135761
    v_fmaak_f32 v49, v49, v38, 0xc0135761
    s_waitcnt lgkmcnt(6)
    v_mfma_f32_32x32x16_bf16 v[80:95], v[64:67], v[120:123], v[80:95]
    ds_read_b64_tr_b16 v[56:57], v30 offset:12288
    ds_read_b64_tr_b16 v[58:59], v30 offset:12800
    v_mul_f32 v48, v48, v96
    v_mul_f32 v49, v49, v97
    v_exp_f32 v48, v48
    s_waitcnt lgkmcnt(6)
    v_mfma_f32_32x32x16_bf16 v[80:95], v[68:71], v[124:127], v[80:95]
    ds_read_b64_tr_b16 v[60:61], v30 offset:14336
    ds_read_b64_tr_b16 v[62:63], v30 offset:14848
    v_exp_f32 v49, v49
    v_mul_f32 v50, v98, v98
    v_add_f32 v48, 1.0, v48
    buffer_store_dwordx4 v[44:47], v36, s[12:15], s26 offen offset:1024
    s_waitcnt lgkmcnt(6)
    v_mfma_f32_32x32x16_bf16 v[80:95], v[72:75], v[128:131], v[80:95]
    ds_read_b64_tr_b16 v[64:65], v30 offset:16384
    ds_read_b64_tr_b16 v[66:67], v30 offset:16896
    v_mul_f32 v51, v99, v99
    v_add_f32 v49, 1.0, v49
    v_fmaak_f32 v50, v50, v38, 0xc0135761
    v_rcp_f32 v48, v48
    s_waitcnt lgkmcnt(6)
    v_mfma_f32_32x32x16_bf16 v[80:95], v[76:79], v[132:135], v[80:95]
    ds_read_b64_tr_b16 v[68:69], v30 offset:18432
    ds_read_b64_tr_b16 v[70:71], v30 offset:18944
    v_fmaak_f32 v51, v51, v38, 0xc0135761
    v_rcp_f32 v49, v49
    v_mul_f32 v50, v50, v98
    s_waitcnt lgkmcnt(6)
    v_mfma_f32_32x32x16_bf16 v[80:95], v[56:59], v[136:139], v[80:95]
    ds_read_b64_tr_b16 v[72:73], v30 offset:20480
    ds_read_b64_tr_b16 v[74:75], v30 offset:20992
    v_mul_f32 v96, v96, v48
    v_mul_f32 v51, v51, v99
    v_mul_f32 v97, v97, v49
    v_exp_f32 v50, v50
    s_waitcnt lgkmcnt(6)
    v_mfma_f32_32x32x16_bf16 v[80:95], v[60:63], v[140:143], v[80:95]
    ds_read_b64_tr_b16 v[76:77], v30 offset:22528
    ds_read_b64_tr_b16 v[78:79], v30 offset:23040
    v_cvt_pk_bf16_f32 v40, v96, v97
    v_exp_f32 v51, v51
    v_mul_f32 v48, v100, v100
    v_add_f32 v50, 1.0, v50
    s_waitcnt lgkmcnt(6)
    v_mfma_f32_32x32x16_bf16 v[80:95], v[64:67], v[144:147], v[80:95]
    ds_read_b64_tr_b16 v[56:57], v30 offset:24576
    ds_read_b64_tr_b16 v[58:59], v30 offset:25088
    v_mul_f32 v49, v101, v101
    v_add_f32 v51, 1.0, v51
    v_fmaak_f32 v48, v48, v38, 0xc0135761
    s_waitcnt lgkmcnt(6)
    v_mfma_f32_32x32x16_bf16 v[80:95], v[68:71], v[148:151], v[80:95]
    ds_read_b64_tr_b16 v[60:61], v30 offset:26624
    ds_read_b64_tr_b16 v[62:63], v30 offset:27136
    v_rcp_f32 v50, v50
    v_fmaak_f32 v49, v49, v38, 0xc0135761
    v_rcp_f32 v51, v51
    s_waitcnt lgkmcnt(6)
    v_mfma_f32_32x32x16_bf16 v[80:95], v[72:75], v[152:155], v[80:95]
    ds_read_b64_tr_b16 v[64:65], v30 offset:28672
    ds_read_b64_tr_b16 v[66:67], v30 offset:29184
    v_mul_f32 v48, v48, v100
    v_mul_f32 v98, v98, v50
    v_mul_f32 v49, v49, v101
    v_mul_f32 v99, v99, v51
    s_waitcnt lgkmcnt(6)
    v_mfma_f32_32x32x16_bf16 v[80:95], v[76:79], v[156:159], v[80:95]
    s_waitcnt vmcnt(2)
    s_barrier
    s_waitcnt lgkmcnt(4)
    v_mfma_f32_32x32x16_bf16 v[80:95], v[56:59], v[160:163], v[80:95]
    ds_read_b64_tr_b16 v[68:69], v30 offset:30720
    ds_read_b64_tr_b16 v[70:71], v30 offset:31232
    ds_read_b64_tr_b16 v[72:73], v30 offset:32768
    ds_read_b64_tr_b16 v[74:75], v30 offset:33280
    v_exp_f32 v48, v48
    v_cvt_pk_bf16_f32 v41, v98, v99
    v_exp_f32 v49, v49
    v_mul_f32 v50, v102, v102
    s_waitcnt lgkmcnt(6)
    v_mfma_f32_32x32x16_bf16 v[80:95], v[60:63], v[164:167], v[80:95]
    ds_read_b64_tr_b16 v[76:77], v30 offset:34816
    ds_read_b64_tr_b16 v[78:79], v30 offset:35328
    v_add_f32 v48, 1.0, v48
    v_mul_f32 v51, v103, v103
    v_add_f32 v49, 1.0, v49
    v_fmaak_f32 v50, v50, v38, 0xc0135761
    s_waitcnt lgkmcnt(6)
    v_mfma_f32_32x32x16_bf16 v[80:95], v[64:67], v[168:171], v[80:95]
    ds_read_b64_tr_b16 v[56:57], v30 offset:36864
    ds_read_b64_tr_b16 v[58:59], v30 offset:37376
    v_rcp_f32 v48, v48
    v_fmaak_f32 v51, v51, v38, 0xc0135761
    v_rcp_f32 v49, v49
    s_waitcnt lgkmcnt(6)
    v_mfma_f32_32x32x16_bf16 v[80:95], v[68:71], v[172:175], v[80:95]
    ds_read_b64_tr_b16 v[60:61], v30 offset:38912
    ds_read_b64_tr_b16 v[62:63], v30 offset:39424
    v_mul_f32 v50, v50, v102
    v_mul_f32 v100, v100, v48
    v_mul_f32 v51, v51, v103
    v_mul_f32 v101, v101, v49
    s_waitcnt lgkmcnt(6)
    v_mfma_f32_32x32x16_bf16 v[80:95], v[72:75], v[176:179], v[80:95]
    ds_read_b64_tr_b16 v[64:65], v30 offset:40960
    ds_read_b64_tr_b16 v[66:67], v30 offset:41472
    v_exp_f32 v50, v50
    v_cvt_pk_bf16_f32 v42, v100, v101
    v_exp_f32 v51, v51
    s_waitcnt lgkmcnt(6)
    v_mfma_f32_32x32x16_bf16 v[80:95], v[76:79], v[180:183], v[80:95]
    ds_read_b64_tr_b16 v[68:69], v30 offset:43008
    ds_read_b64_tr_b16 v[70:71], v30 offset:43520
    v_mul_f32 v48, v104, v104
    v_add_f32 v50, 1.0, v50
    v_mul_f32 v49, v105, v105
    v_add_f32 v51, 1.0, v51
    v_fmaak_f32 v48, v48, v38, 0xc0135761
    s_waitcnt lgkmcnt(6)
    v_mfma_f32_32x32x16_bf16 v[80:95], v[56:59], v[184:187], v[80:95]
    ds_read_b64_tr_b16 v[72:73], v30 offset:45056
    ds_read_b64_tr_b16 v[74:75], v30 offset:45568
    v_rcp_f32 v50, v50
    v_fmaak_f32 v49, v49, v38, 0xc0135761
    v_rcp_f32 v51, v51
    s_mov_b32 s26, s27
    s_waitcnt lgkmcnt(6)
    v_mfma_f32_32x32x16_bf16 v[80:95], v[60:63], v[188:191], v[80:95]
    ds_read_b64_tr_b16 v[76:77], v30 offset:47104
    ds_read_b64_tr_b16 v[78:79], v30 offset:47616
    v_mul_f32 v48, v48, v104
    v_mul_f32 v102, v102, v50
    v_mul_f32 v49, v49, v105
    v_mul_f32 v103, v103, v51
    s_add_u32 s27, s27, 16384
    s_cmp_eq_u32 s25, 0
    s_cselect_b32 s26, s32, s26
    s_waitcnt lgkmcnt(6)
    v_mfma_f32_32x32x16_bf16 v[80:95], v[64:67], v[192:195], v[80:95]
    ds_read_b64_tr_b16 v[56:57], v31 offset:0
    ds_read_b64_tr_b16 v[58:59], v31 offset:512
    v_exp_f32 v48, v48
    v_cvt_pk_bf16_f32 v43, v102, v103
    v_exp_f32 v49, v49
    s_waitcnt lgkmcnt(6)
    v_mfma_f32_32x32x16_bf16 v[80:95], v[68:71], v[196:199], v[80:95]
    ds_read_b64_tr_b16 v[60:61], v31 offset:2048
    ds_read_b64_tr_b16 v[62:63], v31 offset:2560
    v_mul_f32 v50, v106, v106
    v_add_f32 v48, 1.0, v48
    v_mul_f32 v51, v107, v107
    v_add_f32 v49, 1.0, v49
    v_fmaak_f32 v50, v50, v38, 0xc0135761
    s_waitcnt lgkmcnt(6)
    v_mfma_f32_32x32x16_bf16 v[80:95], v[72:75], v[200:203], v[80:95]
    ds_read_b64_tr_b16 v[64:65], v31 offset:4096
    ds_read_b64_tr_b16 v[66:67], v31 offset:4608
    v_rcp_f32 v48, v48
    v_fmaak_f32 v51, v51, v38, 0xc0135761
    s_waitcnt lgkmcnt(6)
    v_mfma_f32_32x32x16_bf16 v[80:95], v[76:79], v[204:207], v[80:95]
    s_waitcnt lgkmcnt(4)
    v_mfma_f32_32x32x16_bf16 v[80:95], v[56:59], v[208:211], v[80:95]
    ds_read_b64_tr_b16 v[68:69], v31 offset:6144
    ds_read_b64_tr_b16 v[70:71], v31 offset:6656
    ds_read_b64_tr_b16 v[72:73], v31 offset:8192
    ds_read_b64_tr_b16 v[74:75], v31 offset:8704
    v_rcp_f32 v49, v49
    v_mul_f32 v50, v50, v106
    v_mul_f32 v104, v104, v48
    v_mul_f32 v51, v51, v107
    v_mul_f32 v105, v105, v49
    s_waitcnt lgkmcnt(6)
    v_mfma_f32_32x32x16_bf16 v[80:95], v[60:63], v[212:215], v[80:95]
    ds_read_b64_tr_b16 v[76:77], v31 offset:10240
    ds_read_b64_tr_b16 v[78:79], v31 offset:10752
    v_exp_f32 v50, v50
    v_cvt_pk_bf16_f32 v44, v104, v105
    v_exp_f32 v51, v51
    s_waitcnt lgkmcnt(6)
    v_mfma_f32_32x32x16_bf16 v[80:95], v[64:67], v[216:219], v[80:95]
    ds_read_b64_tr_b16 v[56:57], v31 offset:12288
    ds_read_b64_tr_b16 v[58:59], v31 offset:12800
    v_mul_f32 v48, v108, v108
    v_add_f32 v50, 1.0, v50
    v_mul_f32 v49, v109, v109
    v_add_f32 v51, 1.0, v51
    s_waitcnt lgkmcnt(6)
    v_mfma_f32_32x32x16_bf16 v[80:95], v[68:71], v[220:223], v[80:95]
    ds_read_b64_tr_b16 v[60:61], v31 offset:14336
    ds_read_b64_tr_b16 v[62:63], v31 offset:14848
    v_fmaak_f32 v48, v48, v38, 0xc0135761
    v_rcp_f32 v50, v50
    v_fmaak_f32 v49, v49, v38, 0xc0135761
    s_waitcnt lgkmcnt(6)
    v_mfma_f32_32x32x16_bf16 v[80:95], v[72:75], v[224:227], v[80:95]
    ds_read_b64_tr_b16 v[64:65], v31 offset:16384
    ds_read_b64_tr_b16 v[66:67], v31 offset:16896
    v_rcp_f32 v51, v51
    v_mul_f32 v48, v48, v108
    v_mul_f32 v106, v106, v50
    v_mul_f32 v49, v49, v109
    v_mul_f32 v107, v107, v51
    s_waitcnt lgkmcnt(6)
    v_mfma_f32_32x32x16_bf16 v[80:95], v[76:79], v[228:231], v[80:95]
    ds_read_b64_tr_b16 v[68:69], v31 offset:18432
    ds_read_b64_tr_b16 v[70:71], v31 offset:18944
    v_exp_f32 v48, v48
    v_cvt_pk_bf16_f32 v45, v106, v107
    s_waitcnt lgkmcnt(6)
    v_mfma_f32_32x32x16_bf16 v[80:95], v[56:59], v[232:235], v[80:95]
    ds_read_b64_tr_b16 v[72:73], v31 offset:20480
    ds_read_b64_tr_b16 v[74:75], v31 offset:20992
    v_exp_f32 v49, v49
    v_mul_f32 v50, v110, v110
    v_add_f32 v48, 1.0, v48
    v_mul_f32 v51, v111, v111
    v_add_f32 v49, 1.0, v49
    s_waitcnt lgkmcnt(6)
    v_mfma_f32_32x32x16_bf16 v[80:95], v[60:63], v[236:239], v[80:95]
    ds_read_b64_tr_b16 v[76:77], v31 offset:22528
    ds_read_b64_tr_b16 v[78:79], v31 offset:23040
    v_fmaak_f32 v50, v50, v38, 0xc0135761
    v_rcp_f32 v48, v48
    v_fmaak_f32 v51, v51, v38, 0xc0135761
    s_waitcnt lgkmcnt(6)
    v_mfma_f32_32x32x16_bf16 v[80:95], v[64:67], v[240:243], v[80:95]
    v_rcp_f32 v49, v49
    v_mul_f32 v50, v50, v110
    v_mul_f32 v108, v108, v48
    v_mul_f32 v51, v51, v111
    s_waitcnt lgkmcnt(4)
    v_mfma_f32_32x32x16_bf16 v[80:95], v[68:71], v[244:247], v[80:95]
    v_mul_f32 v109, v109, v49
    v_exp_f32 v50, v50
    v_cvt_pk_bf16_f32 v46, v108, v109
    s_waitcnt lgkmcnt(2)
    v_mfma_f32_32x32x16_bf16 v[80:95], v[72:75], v[248:251], v[80:95]
    v_exp_f32 v51, v51
    v_add_f32 v50, 1.0, v50
    v_add_f32 v51, 1.0, v51
    v_rcp_f32 v50, v50
    s_waitcnt lgkmcnt(0)
    v_mfma_f32_32x32x16_bf16 v[80:95], v[76:79], v[252:255], v[80:95]
    v_rcp_f32 v51, v51
    v_mul_f32 v110, v110, v50
    v_mul_f32 v111, v111, v51
    v_cvt_pk_bf16_f32 v47, v110, v111
    buffer_store_dwordx4 v[40:43], v36, s[12:15], s26 offen
    buffer_store_dwordx4 v[44:47], v36, s[12:15], s26 offen offset:1024
    s_load_dwordx4 s[36:39], s[0:1], 32
    s_load_dwordx2 s[42:43], s[0:1], 112
    s_load_dwordx2 s[40:41], s[0:1], 72
    s_and_b32 s33, s2, 7
    s_lshr_b32 s34, s2, 3
    s_and_b32 s18, s33, 3
    s_and_b32 s17, s34, 3
    s_waitcnt lgkmcnt(0)

    s_mov_b32 s4, s40
    s_mov_b32 s5, s41
    s_mov_b32 s6, 5308416
    s_mov_b32 s7, 0x00020000
    s_mov_b32 s8, s42
    s_mov_b32 s9, s43
    s_mov_b32 s10, 42991616
    s_mov_b32 s11, 0x00020000
    s_cmp_eq_u32 s17, 3
    s_cbranch_scc1 gated_mix__ssm_conv_h3__dense_activation_gelu__prompt_kernel_tA_conv

    v_mul_f32 v48, v80, v80
    v_mul_f32 v49, v81, v81
    v_fmaak_f32 v48, v48, v38, 0xc0135761
    v_fmaak_f32 v49, v49, v38, 0xc0135761
    v_mul_f32 v48, v48, v80
    v_mul_f32 v49, v49, v81
    v_exp_f32 v48, v48
    v_exp_f32 v49, v49
    v_mul_f32 v50, v82, v82
    v_add_f32 v48, 1.0, v48
    v_mul_f32 v51, v83, v83
    v_add_f32 v49, 1.0, v49
    v_fmaak_f32 v50, v50, v38, 0xc0135761
    v_rcp_f32 v48, v48
    v_fmaak_f32 v51, v51, v38, 0xc0135761
    v_rcp_f32 v49, v49
    v_mul_f32 v50, v50, v82
    v_mul_f32 v80, v80, v48
    v_mul_f32 v51, v51, v83
    v_mul_f32 v81, v81, v49
    v_exp_f32 v50, v50
    v_cvt_pk_bf16_f32 v40, v80, v81
    v_exp_f32 v51, v51
    v_mul_f32 v48, v84, v84
    v_add_f32 v50, 1.0, v50
    v_mul_f32 v49, v85, v85
    v_add_f32 v51, 1.0, v51
    v_fmaak_f32 v48, v48, v38, 0xc0135761
    v_rcp_f32 v50, v50
    v_fmaak_f32 v49, v49, v38, 0xc0135761
    v_rcp_f32 v51, v51
    v_mul_f32 v48, v48, v84
    v_mul_f32 v82, v82, v50
    v_mul_f32 v49, v49, v85
    v_mul_f32 v83, v83, v51
    v_exp_f32 v48, v48
    v_cvt_pk_bf16_f32 v41, v82, v83
    v_exp_f32 v49, v49
    v_mul_f32 v50, v86, v86
    v_add_f32 v48, 1.0, v48
    v_mul_f32 v51, v87, v87
    v_add_f32 v49, 1.0, v49
    v_fmaak_f32 v50, v50, v38, 0xc0135761
    v_rcp_f32 v48, v48
    v_fmaak_f32 v51, v51, v38, 0xc0135761
    v_rcp_f32 v49, v49
    v_mul_f32 v50, v50, v86
    v_mul_f32 v84, v84, v48
    v_mul_f32 v51, v51, v87
    v_mul_f32 v85, v85, v49
    v_exp_f32 v50, v50
    v_cvt_pk_bf16_f32 v42, v84, v85
    v_exp_f32 v51, v51
    v_mul_f32 v48, v88, v88
    v_add_f32 v50, 1.0, v50
    v_mul_f32 v49, v89, v89
    v_add_f32 v51, 1.0, v51
    v_fmaak_f32 v48, v48, v38, 0xc0135761
    v_rcp_f32 v50, v50
    v_fmaak_f32 v49, v49, v38, 0xc0135761
    v_rcp_f32 v51, v51
    v_mul_f32 v48, v48, v88
    v_mul_f32 v86, v86, v50
    v_mul_f32 v49, v49, v89
    v_mul_f32 v87, v87, v51
    v_exp_f32 v48, v48
    v_cvt_pk_bf16_f32 v43, v86, v87
    v_exp_f32 v49, v49
    v_mul_f32 v50, v90, v90
    v_add_f32 v48, 1.0, v48
    v_mul_f32 v51, v91, v91
    v_add_f32 v49, 1.0, v49
    v_fmaak_f32 v50, v50, v38, 0xc0135761
    v_rcp_f32 v48, v48
    v_fmaak_f32 v51, v51, v38, 0xc0135761
    v_rcp_f32 v49, v49
    v_mul_f32 v50, v50, v90
    v_mul_f32 v88, v88, v48
    v_mul_f32 v51, v51, v91
    v_mul_f32 v89, v89, v49
    v_exp_f32 v50, v50
    v_cvt_pk_bf16_f32 v44, v88, v89
    v_exp_f32 v51, v51
    v_mul_f32 v48, v92, v92
    v_add_f32 v50, 1.0, v50
    v_mul_f32 v49, v93, v93
    v_add_f32 v51, 1.0, v51
    v_fmaak_f32 v48, v48, v38, 0xc0135761
    v_rcp_f32 v50, v50
    v_fmaak_f32 v49, v49, v38, 0xc0135761
    v_rcp_f32 v51, v51
    v_mul_f32 v48, v48, v92
    v_mul_f32 v90, v90, v50
    v_mul_f32 v49, v49, v93
    v_mul_f32 v91, v91, v51
    v_exp_f32 v48, v48
    v_cvt_pk_bf16_f32 v45, v90, v91
    v_exp_f32 v49, v49
    v_mul_f32 v50, v94, v94
    v_add_f32 v48, 1.0, v48
    v_mul_f32 v51, v95, v95
    v_add_f32 v49, 1.0, v49
    v_fmaak_f32 v50, v50, v38, 0xc0135761
    v_rcp_f32 v48, v48
    v_fmaak_f32 v51, v51, v38, 0xc0135761
    v_rcp_f32 v49, v49
    v_mul_f32 v50, v50, v94
    v_mul_f32 v92, v92, v48
    v_mul_f32 v51, v51, v95
    v_mul_f32 v93, v93, v49
    v_exp_f32 v50, v50
    v_cvt_pk_bf16_f32 v46, v92, v93
    v_exp_f32 v51, v51
    v_add_f32 v50, 1.0, v50
    v_add_f32 v51, 1.0, v51
    v_rcp_f32 v50, v50
    v_rcp_f32 v51, v51
    v_mul_f32 v94, v94, v50
    v_mul_f32 v95, v95, v51
    v_cvt_pk_bf16_f32 v47, v94, v95
    buffer_store_dwordx4 v[40:43], v36, s[12:15], s59 offen
    buffer_store_dwordx4 v[44:47], v36, s[12:15], s59 offen offset:1024

    v_lshrrev_b32 v11, 5, v1
    v_bfe_u32 v12, v1, 2, 2
    v_lshl_add_u32 v13, v11, 2, v12
    s_movk_i32 s33, 384
    v_mul_lo_u32 v13, v13, s33
    v_bfe_u32 v14, v1, 4, 1
    v_lshl_add_u32 v13, v14, 5, v13
    v_and_b32 v14, 1, v1
    v_lshl_add_u32 v13, v14, 4, v13
    v_bfe_u32 v14, v1, 1, 1
    v_lshl_add_u32 v13, v14, 3, v13
    v_lshrrev_b32 v12, 1, v12
    v_lshlrev_b32 v12, 6, v12
    v_add_u32 v8, v13, v12
    v_sub_u32 v9, v13, v12
    v_lshlrev_b32 v10, 4, v1
    s_lshl_b32 s33, s20, 11
    s_add_u32 s33, s33, 12288
    v_add_u32 v10, s33, v10
    v_add_u32 v4, 81920, v8
    v_add_u32 v5, 81920, v9
    v_add_u32 v6, 81920, v10
    s_mov_b32 s22, 81920
    s_mov_b32 s25, 0

    v_mov_b32 v64, 0
    v_mov_b32 v65, 0
    v_mov_b32 v66, 0
    v_mov_b32 v67, 0
    v_mov_b32 v68, 0
    v_mov_b32 v69, 0
    v_mov_b32 v70, 0
    v_mov_b32 v71, 0
    v_mov_b32 v72, 0
    v_mov_b32 v73, 0
    v_mov_b32 v74, 0
    v_mov_b32 v75, 0
    v_mov_b32 v76, 0
    v_mov_b32 v77, 0
    v_mov_b32 v78, 0
    v_mov_b32 v79, 0
    v_mov_b32 v80, 0
    v_mov_b32 v81, 0
    v_mov_b32 v82, 0
    v_mov_b32 v83, 0
    v_mov_b32 v84, 0
    v_mov_b32 v85, 0
    v_mov_b32 v86, 0
    v_mov_b32 v87, 0
    v_mov_b32 v88, 0
    v_mov_b32 v89, 0
    v_mov_b32 v90, 0
    v_mov_b32 v91, 0
    v_mov_b32 v92, 0
    v_mov_b32 v93, 0
    v_mov_b32 v94, 0
    v_mov_b32 v95, 0
    v_mov_b32 v96, 0
    v_mov_b32 v97, 0
    v_mov_b32 v98, 0
    v_mov_b32 v99, 0
    v_mov_b32 v100, 0
    v_mov_b32 v101, 0
    v_mov_b32 v102, 0
    v_mov_b32 v103, 0
    v_mov_b32 v104, 0
    v_mov_b32 v105, 0
    v_mov_b32 v106, 0
    v_mov_b32 v107, 0
    v_mov_b32 v108, 0
    v_mov_b32 v109, 0
    v_mov_b32 v110, 0
    v_mov_b32 v111, 0
    v_mov_b32 v112, 0
    v_mov_b32 v113, 0
    v_mov_b32 v114, 0
    v_mov_b32 v115, 0
    v_mov_b32 v116, 0
    v_mov_b32 v117, 0
    v_mov_b32 v118, 0
    v_mov_b32 v119, 0
    v_mov_b32 v120, 0
    v_mov_b32 v121, 0
    v_mov_b32 v122, 0
    v_mov_b32 v123, 0
    v_mov_b32 v124, 0
    v_mov_b32 v125, 0
    v_mov_b32 v126, 0
    v_mov_b32 v127, 0
    v_mov_b32 v128, 0
    v_mov_b32 v129, 0
    v_mov_b32 v130, 0
    v_mov_b32 v131, 0
    v_mov_b32 v132, 0
    v_mov_b32 v133, 0
    v_mov_b32 v134, 0
    v_mov_b32 v135, 0
    v_mov_b32 v136, 0
    v_mov_b32 v137, 0
    v_mov_b32 v138, 0
    v_mov_b32 v139, 0
    v_mov_b32 v140, 0
    v_mov_b32 v141, 0
    v_mov_b32 v142, 0
    v_mov_b32 v143, 0
    v_mov_b32 v144, 0
    v_mov_b32 v145, 0
    v_mov_b32 v146, 0
    v_mov_b32 v147, 0
    v_mov_b32 v148, 0
    v_mov_b32 v149, 0
    v_mov_b32 v150, 0
    v_mov_b32 v151, 0
    v_mov_b32 v152, 0
    v_mov_b32 v153, 0
    v_mov_b32 v154, 0
    v_mov_b32 v155, 0
    v_mov_b32 v156, 0
    v_mov_b32 v157, 0
    v_mov_b32 v158, 0
    v_mov_b32 v159, 0
    s_waitcnt vmcnt(0)
    s_barrier

    s_branch gated_mix__ssm_conv_h3__dense_activation_gelu__prompt_kernel_afterY
gated_mix__ssm_conv_h3__dense_activation_gelu__prompt_kernel_tA_conv:
    v_mul_f32 v48, v80, v80
    v_mul_f32 v49, v81, v81
    v_fmaak_f32 v48, v48, v38, 0xc0135761
    v_fmaak_f32 v49, v49, v38, 0xc0135761
    v_mul_f32 v48, v48, v80
    v_mul_f32 v49, v49, v81
    v_exp_f32 v48, v48
    v_exp_f32 v49, v49
    v_mul_f32 v50, v82, v82
    v_add_f32 v48, 1.0, v48
    v_mul_f32 v51, v83, v83
    v_add_f32 v49, 1.0, v49
    v_fmaak_f32 v50, v50, v38, 0xc0135761
    v_rcp_f32 v48, v48
    v_fmaak_f32 v51, v51, v38, 0xc0135761
    v_rcp_f32 v49, v49
    v_mul_f32 v50, v50, v82
    v_mul_f32 v80, v80, v48
    v_mul_f32 v51, v51, v83
    v_mul_f32 v81, v81, v49
    v_exp_f32 v50, v50
    v_cvt_pk_bf16_f32 v40, v80, v81
    v_exp_f32 v51, v51
    v_mul_f32 v48, v84, v84
    v_add_f32 v50, 1.0, v50
    v_mul_f32 v49, v85, v85
    v_add_f32 v51, 1.0, v51
    v_fmaak_f32 v48, v48, v38, 0xc0135761
    v_rcp_f32 v50, v50
    v_fmaak_f32 v49, v49, v38, 0xc0135761
    v_rcp_f32 v51, v51
    v_mul_f32 v48, v48, v84
    v_mul_f32 v82, v82, v50
    v_mul_f32 v49, v49, v85
    v_mul_f32 v83, v83, v51
    v_exp_f32 v48, v48
    v_cvt_pk_bf16_f32 v41, v82, v83
    v_exp_f32 v49, v49
    v_mul_f32 v50, v86, v86
    v_add_f32 v48, 1.0, v48
    v_mul_f32 v51, v87, v87
    v_add_f32 v49, 1.0, v49
    v_fmaak_f32 v50, v50, v38, 0xc0135761
    v_rcp_f32 v48, v48
    v_fmaak_f32 v51, v51, v38, 0xc0135761
    v_rcp_f32 v49, v49
    v_mul_f32 v50, v50, v86
    v_mul_f32 v84, v84, v48
    v_mul_f32 v51, v51, v87
    v_mul_f32 v85, v85, v49
    v_exp_f32 v50, v50
    v_cvt_pk_bf16_f32 v42, v84, v85
    v_exp_f32 v51, v51
    v_mul_f32 v48, v88, v88
    v_add_f32 v50, 1.0, v50
    v_mul_f32 v49, v89, v89
    v_add_f32 v51, 1.0, v51
    v_fmaak_f32 v48, v48, v38, 0xc0135761
    v_rcp_f32 v50, v50
    v_fmaak_f32 v49, v49, v38, 0xc0135761
    v_rcp_f32 v51, v51
    v_mul_f32 v48, v48, v88
    v_mul_f32 v86, v86, v50
    v_mul_f32 v49, v49, v89
    v_mul_f32 v87, v87, v51
    v_exp_f32 v48, v48
    v_cvt_pk_bf16_f32 v43, v86, v87
    v_exp_f32 v49, v49
    v_mul_f32 v50, v90, v90
    v_add_f32 v48, 1.0, v48
    v_mul_f32 v51, v91, v91
    v_add_f32 v49, 1.0, v49
    v_fmaak_f32 v50, v50, v38, 0xc0135761
    v_rcp_f32 v48, v48
    v_fmaak_f32 v51, v51, v38, 0xc0135761
    v_rcp_f32 v49, v49
    v_mul_f32 v50, v50, v90
    v_mul_f32 v88, v88, v48
    v_mul_f32 v51, v51, v91
    v_mul_f32 v89, v89, v49
    v_exp_f32 v50, v50
    v_cvt_pk_bf16_f32 v44, v88, v89
    v_exp_f32 v51, v51
    v_mul_f32 v48, v92, v92
    v_add_f32 v50, 1.0, v50
    v_mul_f32 v49, v93, v93
    v_add_f32 v51, 1.0, v51
    v_fmaak_f32 v48, v48, v38, 0xc0135761
    v_rcp_f32 v50, v50
    v_fmaak_f32 v49, v49, v38, 0xc0135761
    v_rcp_f32 v51, v51
    v_mul_f32 v48, v48, v92
    v_mul_f32 v90, v90, v50
    v_mul_f32 v49, v49, v93
    v_mul_f32 v91, v91, v51
    v_exp_f32 v48, v48
    v_cvt_pk_bf16_f32 v45, v90, v91
    v_exp_f32 v49, v49
    v_mul_f32 v50, v94, v94
    v_add_f32 v48, 1.0, v48
    v_mul_f32 v51, v95, v95
    v_add_f32 v49, 1.0, v49
    v_fmaak_f32 v50, v50, v38, 0xc0135761
    v_rcp_f32 v48, v48
    v_fmaak_f32 v51, v51, v38, 0xc0135761
    v_rcp_f32 v49, v49
    v_mul_f32 v50, v50, v94
    v_mul_f32 v92, v92, v48
    v_mul_f32 v51, v51, v95
    v_mul_f32 v93, v93, v49
    v_exp_f32 v50, v50
    v_cvt_pk_bf16_f32 v46, v92, v93
    v_exp_f32 v51, v51
    v_add_f32 v50, 1.0, v50
    v_add_f32 v51, 1.0, v51
    v_rcp_f32 v50, v50
    v_rcp_f32 v51, v51
    v_mul_f32 v94, v94, v50
    v_mul_f32 v95, v95, v51
    v_cvt_pk_bf16_f32 v47, v94, v95
    buffer_store_dwordx4 v[40:43], v36, s[12:15], s59 offen
    buffer_store_dwordx4 v[44:47], v36, s[12:15], s59 offen offset:1024
    s_waitcnt vmcnt(0)
    v_mov_b32 v2, 81600
    v_mov_b32 v3, 1
    s_mov_b64 exec, 1
    ds_add_u32 v2, v3
    ds_add_u32 v2, v3 offset:4
    s_mov_b64 exec, -1
    s_mov_b32 s33, 0
    gated_mix__ssm_conv_h3__dense_activation_gelu__prompt_kernel_cntA:
    ds_read_b64 v[4:5], v2
    s_waitcnt lgkmcnt(0)
    v_readfirstlane_b32 s34, v4
    v_readfirstlane_b32 s35, v5
    s_add_u32 s33, s33, 1
    s_cmp_ge_u32 s33, 262144
    s_cbranch_scc1 gated_mix__ssm_conv_h3__dense_activation_gelu__prompt_kernel_cntAd
    s_cmp_lt_u32 s35, 4
    s_cbranch_scc1 gated_mix__ssm_conv_h3__dense_activation_gelu__prompt_kernel_cntAs
    s_cmp_lg_u32 s98, 0
    s_cbranch_scc1 gated_mix__ssm_conv_h3__dense_activation_gelu__prompt_kernel_cntAd
    s_cmp_lt_u32 s34, 8
    s_cbranch_scc0 gated_mix__ssm_conv_h3__dense_activation_gelu__prompt_kernel_cntAd
    gated_mix__ssm_conv_h3__dense_activation_gelu__prompt_kernel_cntAs:
    s_sleep 2
    s_branch gated_mix__ssm_conv_h3__dense_activation_gelu__prompt_kernel_cntA
    gated_mix__ssm_conv_h3__dense_activation_gelu__prompt_kernel_cntAd:
    s_cmp_lg_u32 s98, 0
    s_cbranch_scc1 gated_mix__ssm_conv_h3__dense_activation_gelu__prompt_kernel_convA_go
    ds_read_b32 v4, v2 offset:8
    s_waitcnt lgkmcnt(0)
    v_readfirstlane_b32 s77, v4
    s_nop 3
    s_cmp_eq_u32 s77, 1
    s_cbranch_scc1 gated_mix__ssm_conv_h3__dense_activation_gelu__prompt_kernel_same5c
    buffer_wbl2 sc1
    s_waitcnt vmcnt(0)
    gated_mix__ssm_conv_h3__dense_activation_gelu__prompt_kernel_same5c:

    v_mov_b32 v6, 163520
    ds_read_b64 v[4:5], v6
    s_waitcnt lgkmcnt(0)
    v_readfirstlane_b32 s96, v4
    v_readfirstlane_b32 s97, v5
    s_nop 3

    s_or_b32 s33, s96, 5
    v_mov_b32 v2, s33
    v_mov_b32 v3, s97
    s_lshl_b32 s33, s21, 6
    v_mov_b32 v4, s33
    s_mov_b64 s[30:31], exec
    s_mov_b64 exec, 1
    buffer_store_dwordx2 v[2:3], v4, s[92:95], 0 offen sc1
    s_mov_b64 exec, s[30:31]

gated_mix__ssm_conv_h3__dense_activation_gelu__prompt_kernel_convA_go:
    s_mov_b32 s19, 0
    s_branch gated_mix__ssm_conv_h3__dense_activation_gelu__prompt_kernel_conv
gated_mix__ssm_conv_h3__dense_activation_gelu__prompt_kernel_tailB:
    buffer_store_dwordx4 v[40:43], v36, s[12:15], s26 offen
    buffer_store_dwordx4 v[44:47], v36, s[12:15], s26 offen offset:1024
    s_nop 1
    v_mul_f32 v48, v96, v96
    v_mul_f32 v49, v97, v97
    v_fmaak_f32 v48, v48, v38, 0xc0135761
    v_fmaak_f32 v49, v49, v38, 0xc0135761
    v_mul_f32 v48, v48, v96
    v_mul_f32 v49, v49, v97
    v_exp_f32 v48, v48
    v_exp_f32 v49, v49
    v_mul_f32 v50, v98, v98
    v_add_f32 v48, 1.0, v48
    v_mul_f32 v51, v99, v99
    v_add_f32 v49, 1.0, v49
    v_fmaak_f32 v50, v50, v38, 0xc0135761
    v_rcp_f32 v48, v48
    v_fmaak_f32 v51, v51, v38, 0xc0135761
    v_rcp_f32 v49, v49
    v_mul_f32 v50, v50, v98
    v_mul_f32 v96, v96, v48
    v_mul_f32 v51, v51, v99
    v_mul_f32 v97, v97, v49
    v_exp_f32 v50, v50
    v_cvt_pk_bf16_f32 v40, v96, v97
    v_exp_f32 v51, v51
    v_mul_f32 v48, v100, v100
    v_add_f32 v50, 1.0, v50
    v_mul_f32 v49, v101, v101
    v_add_f32 v51, 1.0, v51
    v_fmaak_f32 v48, v48, v38, 0xc0135761
    v_rcp_f32 v50, v50
    v_fmaak_f32 v49, v49, v38, 0xc0135761
    v_rcp_f32 v51, v51
    v_mul_f32 v48, v48, v100
    v_mul_f32 v98, v98, v50
    v_mul_f32 v49, v49, v101
    v_mul_f32 v99, v99, v51
    v_exp_f32 v48, v48
    v_cvt_pk_bf16_f32 v41, v98, v99
    v_exp_f32 v49, v49
    v_mul_f32 v50, v102, v102
    v_add_f32 v48, 1.0, v48
    v_mul_f32 v51, v103, v103
    v_add_f32 v49, 1.0, v49
    v_fmaak_f32 v50, v50, v38, 0xc0135761
    v_rcp_f32 v48, v48
    v_fmaak_f32 v51, v51, v38, 0xc0135761
    v_rcp_f32 v49, v49
    v_mul_f32 v50, v50, v102
    v_mul_f32 v100, v100, v48
    v_mul_f32 v51, v51, v103
    v_mul_f32 v101, v101, v49
    v_exp_f32 v50, v50
    v_cvt_pk_bf16_f32 v42, v100, v101
    v_exp_f32 v51, v51
    v_mul_f32 v48, v104, v104
    v_add_f32 v50, 1.0, v50
    v_mul_f32 v49, v105, v105
    v_add_f32 v51, 1.0, v51
    v_fmaak_f32 v48, v48, v38, 0xc0135761
    v_rcp_f32 v50, v50
    v_fmaak_f32 v49, v49, v38, 0xc0135761
    v_rcp_f32 v51, v51
    v_mul_f32 v48, v48, v104
    v_mul_f32 v102, v102, v50
    v_mul_f32 v49, v49, v105
    v_mul_f32 v103, v103, v51
    v_exp_f32 v48, v48
    v_cvt_pk_bf16_f32 v43, v102, v103
    v_exp_f32 v49, v49
    v_mul_f32 v50, v106, v106
    v_add_f32 v48, 1.0, v48
    v_mul_f32 v51, v107, v107
    v_add_f32 v49, 1.0, v49
    v_fmaak_f32 v50, v50, v38, 0xc0135761
    v_rcp_f32 v48, v48
    v_fmaak_f32 v51, v51, v38, 0xc0135761
    v_rcp_f32 v49, v49
    v_mul_f32 v50, v50, v106
    v_mul_f32 v104, v104, v48
    v_mul_f32 v51, v51, v107
    v_mul_f32 v105, v105, v49
    v_exp_f32 v50, v50
    v_cvt_pk_bf16_f32 v44, v104, v105
    v_exp_f32 v51, v51
    v_mul_f32 v48, v108, v108
    v_add_f32 v50, 1.0, v50
    v_mul_f32 v49, v109, v109
    v_add_f32 v51, 1.0, v51
    v_fmaak_f32 v48, v48, v38, 0xc0135761
    v_rcp_f32 v50, v50
    v_fmaak_f32 v49, v49, v38, 0xc0135761
    v_rcp_f32 v51, v51
    v_mul_f32 v48, v48, v108
    v_mul_f32 v106, v106, v50
    v_mul_f32 v49, v49, v109
    v_mul_f32 v107, v107, v51
    v_exp_f32 v48, v48
    v_cvt_pk_bf16_f32 v45, v106, v107
    v_exp_f32 v49, v49
    v_mul_f32 v50, v110, v110
    v_add_f32 v48, 1.0, v48
    v_mul_f32 v51, v111, v111
    v_add_f32 v49, 1.0, v49
    v_fmaak_f32 v50, v50, v38, 0xc0135761
    v_rcp_f32 v48, v48
    v_fmaak_f32 v51, v51, v38, 0xc0135761
    v_rcp_f32 v49, v49
    v_mul_f32 v50, v50, v110
    v_mul_f32 v108, v108, v48
    v_mul_f32 v51, v51, v111
    v_mul_f32 v109, v109, v49
    v_exp_f32 v50, v50
    v_cvt_pk_bf16_f32 v46, v108, v109
    v_exp_f32 v51, v51
    v_add_f32 v50, 1.0, v50
    v_add_f32 v51, 1.0, v51
    v_rcp_f32 v50, v50
    v_rcp_f32 v51, v51
    v_mul_f32 v110, v110, v50
    v_mul_f32 v111, v111, v51
    v_cvt_pk_bf16_f32 v47, v110, v111
    s_waitcnt vmcnt(2)
    s_barrier
    buffer_store_dwordx4 v[40:43], v36, s[12:15], s27 offen
    buffer_store_dwordx4 v[44:47], v36, s[12:15], s27 offen offset:1024

    s_load_dwordx4 s[36:39], s[0:1], 32
    s_load_dwordx2 s[42:43], s[0:1], 112
    s_load_dwordx2 s[40:41], s[0:1], 72
    s_and_b32 s33, s2, 7
    s_lshr_b32 s34, s2, 3
    s_and_b32 s18, s33, 3
    s_and_b32 s17, s34, 3
    s_waitcnt lgkmcnt(0)

    s_mov_b32 s4, s40
    s_mov_b32 s5, s41
    s_mov_b32 s6, 5308416
    s_mov_b32 s7, 0x00020000
    s_mov_b32 s8, s42
    s_mov_b32 s9, s43
    s_mov_b32 s10, 42991616
    s_mov_b32 s11, 0x00020000
    s_cmp_eq_u32 s17, 3
    s_cbranch_scc1 gated_mix__ssm_conv_h3__dense_activation_gelu__prompt_kernel_tB_conv
    v_add_u32 v4, 0, v1
    s_movk_i32 s33, 2731
    v_mul_lo_u32 v5, v4, s33
    v_lshrrev_b32 v5, 16, v5
    v_mul_u32_u24 v6, 24, v5
    v_sub_u32 v6, v4, v6
    v_bfe_u32 v7, v5, 1, 1
    v_lshlrev_b32 v7, 2, v7
    v_xor_b32 v6, v6, v7
    s_movk_i32 s33, 1152
    v_mul_lo_u32 v5, v5, s33
    v_lshl_add_u32 v10, v6, 4, v5

    v_add_u32 v4, 64, v1
    s_movk_i32 s33, 2731
    v_mul_lo_u32 v5, v4, s33
    v_lshrrev_b32 v5, 16, v5
    v_mul_u32_u24 v6, 24, v5
    v_sub_u32 v6, v4, v6
    v_bfe_u32 v7, v5, 1, 1
    v_lshlrev_b32 v7, 2, v7
    v_xor_b32 v6, v6, v7
    s_movk_i32 s33, 1152
    v_mul_lo_u32 v5, v5, s33
    v_lshl_add_u32 v11, v6, 4, v5

    v_add_u32 v4, 128, v1
    s_movk_i32 s33, 2731
    v_mul_lo_u32 v5, v4, s33
    v_lshrrev_b32 v5, 16, v5
    v_mul_u32_u24 v6, 24, v5
    v_sub_u32 v6, v4, v6
    v_bfe_u32 v7, v5, 1, 1
    v_lshlrev_b32 v7, 2, v7
    v_xor_b32 v6, v6, v7
    s_movk_i32 s33, 1152
    v_mul_lo_u32 v5, v5, s33
    v_lshl_add_u32 v12, v6, 4, v5

    v_lshlrev_b32 v13, 4, v1
    s_mul_i32 s52, s18, 1327104
    s_mul_i32 s33, s20, 9216
    s_add_u32 s52, s52, s33
    s_mul_i32 s33, s17, 384
    s_add_u32 s52, s52, s33
    s_mul_i32 s53, s16, 1179648
    s_mul_i32 s33, s18, 294912
    s_add_u32 s53, s53, s33
    s_lshl_b32 s33, s20, 11
    s_add_u32 s53, s53, s33
    s_add_u32 s53, s53, 5242880
    s_mul_i32 s54, s20, 3072
    s_lshl_b32 s55, s20, 11
    s_add_u32 s55, s55, 12288
    s_mov_b32 s22, 81920

    s_mov_b32 s60, 0x122ca040
    s_mov_b32 s61, 0x309d713
    s_mov_b32 s62, 0x1e55434c
    s_mov_b32 s63, 0xf38511f
    s_mov_b32 s64, 0x68605d6
    s_mov_b32 s65, 0x19611407
    s_mov_b32 s66, 0x1a2488e2
    s_mov_b32 s67, 0x1b
    s_mov_b32 s57, 0
    v_mov_b32 v18, 163520
    ds_read_b64 v[16:17], v18
    s_waitcnt lgkmcnt(0)
    v_readfirstlane_b32 s96, v16
    v_readfirstlane_b32 s97, v17
    s_nop 3

    s_lshl_b32 s33, s16, 4
    s_lshl_b32 s34, s18, 2
    s_add_u32 s33, s33, s34
    s_add_u32 s33, s33, 208
    v_add_u32 v16, s33, v1
    v_lshlrev_b32 v16, 6, v16
    v_cmp_gt_u32 vcc, 4, v1
    v_mov_b32 v17, 0
    v_mov_b32 v18, 2
    s_nop 0
    v_cndmask_b32 v17, v17, v18, vcc

    s_mov_b32 s33, 0
    Lfp2:
    buffer_load_dwordx2 v[18:19], v16, s[92:95], 0 offen sc1
    s_waitcnt vmcnt(0)
    v_subrev_u32 v18, s96, v18
    v_cmp_eq_u32 vcc, s97, v19
    v_cmp_ge_u32 s[34:35], v18, v17
    s_and_b64 vcc, vcc, s[34:35]
    v_cmp_gt_u32 s[34:35], 16, v18
    s_and_b64 vcc, vcc, s[34:35]
    v_cmp_eq_u32 s[34:35], 0, v17
    s_or_b64 vcc, vcc, s[34:35]
    s_add_u32 s33, s33, 1
    s_cmp_ge_u32 s33, 262144
    s_cbranch_scc1 Lfp2_d
    s_cmp_eq_u64 vcc, exec
    s_cbranch_scc1 Lfp2_d
    s_sleep 1
    s_branch Lfp2
    Lfp2_d:

    s_mov_b32 s58, 0
gated_mix__ssm_conv_h3__dense_activation_gelu__prompt_kernel_pro_l:
    s_and_b32 s56, s60, 63
    s_lshr_b32 s60, s60, 6
    s_add_u32 s57, s57, 1
    s_cmp_eq_u32 s57, 5
    s_cbranch_scc0 gated_mix__ssm_conv_h3__dense_activation_gelu__prompt_kernel_rot2909
    s_mov_b32 s60, s61
    s_mov_b32 s61, s62
    s_mov_b32 s62, s63
    s_mov_b32 s63, s64
    s_mov_b32 s64, s65
    s_mov_b32 s65, s66
    s_mov_b32 s66, s67
    s_mov_b32 s57, 0
gated_mix__ssm_conv_h3__dense_activation_gelu__prompt_kernel_rot2909:
    s_mul_i32 s34, s56, 36864
    s_add_u32 s34, s34, s52
    s_lshl_b32 s35, s56, 13
    s_add_u32 s35, s35, s53
    s_add_u32 s33, s22, s54
    s_add_u32 m0, s33, 0
    s_nop 0
    buffer_load_dwordx4 v10, s[4:7], s34 offen lds
    s_add_u32 s33, s22, s54
    s_add_u32 m0, s33, 1024
    s_nop 0
    buffer_load_dwordx4 v11, s[4:7], s34 offen lds
    s_add_u32 s33, s22, s54
    s_add_u32 m0, s33, 2048
    s_nop 0
    buffer_load_dwordx4 v12, s[4:7], s34 offen lds
    s_add_u32 s33, s22, s55
    s_add_u32 m0, s33, 0
    s_add_u32 s33, s35, 0
    buffer_load_dwordx4 v13, s[8:11], s33 offen sc1 lds
    s_add_u32 s33, s22, s55
    s_add_u32 m0, s33, 1024
    s_add_u32 s33, s35, 1024
    buffer_load_dwordx4 v13, s[8:11], s33 offen sc1 lds
    s_add_u32 s22, s22, 20480
    s_cmp_ge_u32 s22, 143360
    s_cselect_b32 s22, 0, s22
    s_add_u32 s58, s58, 1
    s_cmp_lt_u32 s58, 3
    s_cbranch_scc1 gated_mix__ssm_conv_h3__dense_activation_gelu__prompt_kernel_pro_l
    s_waitcnt vmcnt(15)
    s_barrier
    s_mov_b32 s58, 0
gated_mix__ssm_conv_h3__dense_activation_gelu__prompt_kernel_pro2_l:
    s_and_b32 s56, s60, 63
    s_lshr_b32 s60, s60, 6
    s_add_u32 s57, s57, 1
    s_cmp_eq_u32 s57, 5
    s_cbranch_scc0 gated_mix__ssm_conv_h3__dense_activation_gelu__prompt_kernel_rot2957
    s_mov_b32 s60, s61
    s_mov_b32 s61, s62
    s_mov_b32 s62, s63
    s_mov_b32 s63, s64
    s_mov_b32 s64, s65
    s_mov_b32 s65, s66
    s_mov_b32 s66, s67
    s_mov_b32 s57, 0
gated_mix__ssm_conv_h3__dense_activation_gelu__prompt_kernel_rot2957:
    s_mul_i32 s34, s56, 36864
    s_add_u32 s34, s34, s52
    s_lshl_b32 s35, s56, 13
    s_add_u32 s35, s35, s53
    s_add_u32 s33, s22, s54
    s_add_u32 m0, s33, 0
    s_nop 0
    buffer_load_dwordx4 v10, s[4:7], s34 offen lds
    s_add_u32 s33, s22, s54
    s_add_u32 m0, s33, 1024
    s_nop 0
    buffer_load_dwordx4 v11, s[4:7], s34 offen lds
    s_add_u32 s33, s22, s54
    s_add_u32 m0, s33, 2048
    s_nop 0
    buffer_load_dwordx4 v12, s[4:7], s34 offen lds
    s_add_u32 s33, s22, s55
    s_add_u32 m0, s33, 0
    s_add_u32 s33, s35, 0
    buffer_load_dwordx4 v13, s[8:11], s33 offen sc1 lds
    s_add_u32 s33, s22, s55
    s_add_u32 m0, s33, 1024
    s_add_u32 s33, s35, 1024
    buffer_load_dwordx4 v13, s[8:11], s33 offen sc1 lds
    s_add_u32 s22, s22, 20480
    s_cmp_ge_u32 s22, 143360
    s_cselect_b32 s22, 0, s22
    s_add_u32 s58, s58, 1
    s_cmp_lt_u32 s58, 3
    s_cbranch_scc1 gated_mix__ssm_conv_h3__dense_activation_gelu__prompt_kernel_pro2_l
    s_branch gated_mix__ssm_conv_h3__dense_activation_gelu__prompt_kernel_afterY
gated_mix__ssm_conv_h3__dense_activation_gelu__prompt_kernel_tB_conv:
    s_mov_b32 s19, 1
    s_branch gated_mix__ssm_conv_h3__dense_activation_gelu__prompt_kernel_conv
gated_mix__ssm_conv_h3__dense_activation_gelu__prompt_kernel_afterY:
    s_cmp_lg_u32 s98, 7
    s_cbranch_scc1 gated_mix__ssm_conv_h3__dense_activation_gelu__prompt_kernel_nof5
    s_cmp_eq_u32 s77, 1
    s_cbranch_scc1 gated_mix__ssm_conv_h3__dense_activation_gelu__prompt_kernel_same5
    buffer_wbl2 sc1
    s_waitcnt vmcnt(0)
    gated_mix__ssm_conv_h3__dense_activation_gelu__prompt_kernel_same5:

    s_or_b32 s33, s96, 5
    v_mov_b32 v2, s33
    v_mov_b32 v3, s97
    s_lshl_b32 s33, s21, 6
    v_mov_b32 v4, s33
    s_mov_b64 s[30:31], exec
    s_mov_b64 exec, 1
    buffer_store_dwordx2 v[2:3], v4, s[92:95], 0 offen sc1
    s_mov_b64 exec, s[30:31]

gated_mix__ssm_conv_h3__dense_activation_gelu__prompt_kernel_nof5:
    s_cmp_eq_u32 s17, 3
    s_cbranch_scc1 gated_mix__ssm_conv_h3__dense_activation_gelu__prompt_kernel_conv

    s_cmp_ge_u32 s98, 4
    s_cbranch_scc1 gated_mix__ssm_conv_h3__dense_activation_gelu__prompt_kernel_prod
    s_barrier
    ds_read_b128 v[40:43], v6 offset:0
    ds_read_b128 v[44:47], v6 offset:1024
    ds_read_b64_tr_b16 v[16:17], v4 offset:0
    ds_read_b64_tr_b16 v[18:19], v4 offset:3072
    ds_read_b64_tr_b16 v[20:21], v5 offset:64
    ds_read_b64_tr_b16 v[22:23], v5 offset:3136
    ds_read_b64_tr_b16 v[24:25], v4 offset:128
    ds_read_b64_tr_b16 v[26:27], v4 offset:3200
    ds_read_b64_tr_b16 v[28:29], v5 offset:192
    ds_read_b64_tr_b16 v[30:31], v5 offset:3264
    s_waitcnt lgkmcnt(0)
.p2align 6
gated_mix__ssm_conv_h3__dense_activation_gelu__prompt_kernel_cloop:
    s_waitcnt lgkmcnt(6)
    v_mfma_f32_32x32x16_bf16 v[64:79], v[16:19], v[40:43], v[64:79]
    s_add_u32 s22, s22, 20480
    s_cmp_ge_u32 s22, 143360
    ds_read_b64_tr_b16 v[32:33], v4 offset:256
    ds_read_b64_tr_b16 v[34:35], v4 offset:3328
    s_waitcnt lgkmcnt(6)
    v_mfma_f32_32x32x16_bf16 v[80:95], v[20:23], v[40:43], v[80:95]
    s_cselect_b32 s22, 0, s22
    v_add_u32 v6, s22, v10
    ds_read_b64_tr_b16 v[36:37], v5 offset:320
    ds_read_b64_tr_b16 v[38:39], v5 offset:3392
    s_waitcnt lgkmcnt(6)
    v_mfma_f32_32x32x16_bf16 v[96:111], v[24:27], v[40:43], v[96:111]
    ds_read_b64_tr_b16 v[16:17], v4 offset:6144
    ds_read_b64_tr_b16 v[18:19], v4 offset:9216
    ds_read_b128 v[48:51], v6 offset:0
    s_waitcnt lgkmcnt(7)
    v_mfma_f32_32x32x16_bf16 v[112:127], v[28:31], v[40:43], v[112:127]
    ds_read_b64_tr_b16 v[20:21], v5 offset:6208
    ds_read_b64_tr_b16 v[22:23], v5 offset:9280
    ds_read_b128 v[52:55], v6 offset:1024
    s_waitcnt lgkmcnt(8)
    v_mfma_f32_32x32x16_bf16 v[128:143], v[32:35], v[40:43], v[128:143]
    ds_read_b64_tr_b16 v[24:25], v4 offset:6272
    ds_read_b64_tr_b16 v[26:27], v4 offset:9344
    s_waitcnt lgkmcnt(8)
    v_mfma_f32_32x32x16_bf16 v[144:159], v[36:39], v[40:43], v[144:159]
    ds_read_b64_tr_b16 v[28:29], v5 offset:6336
    ds_read_b64_tr_b16 v[30:31], v5 offset:9408
    s_waitcnt lgkmcnt(8)
    v_mfma_f32_32x32x16_bf16 v[64:79], v[16:19], v[44:47], v[64:79]
    ds_read_b64_tr_b16 v[32:33], v4 offset:6400
    ds_read_b64_tr_b16 v[34:35], v4 offset:9472
    s_waitcnt lgkmcnt(7)
    v_mfma_f32_32x32x16_bf16 v[80:95], v[20:23], v[44:47], v[80:95]
    ds_read_b64_tr_b16 v[36:37], v5 offset:6464
    ds_read_b64_tr_b16 v[38:39], v5 offset:9536
    v_add_u32 v4, s22, v8
    s_waitcnt lgkmcnt(6)
    v_mfma_f32_32x32x16_bf16 v[96:111], v[24:27], v[44:47], v[96:111]
    v_add_u32 v5, s22, v9
    ds_read_b64_tr_b16 v[16:17], v4 offset:0
    ds_read_b64_tr_b16 v[18:19], v4 offset:3072
    s_waitcnt lgkmcnt(6)
    v_mfma_f32_32x32x16_bf16 v[112:127], v[28:31], v[44:47], v[112:127]
    ds_read_b64_tr_b16 v[20:21], v5 offset:64
    ds_read_b64_tr_b16 v[22:23], v5 offset:3136
    s_waitcnt lgkmcnt(6)
    v_mfma_f32_32x32x16_bf16 v[128:143], v[32:35], v[44:47], v[128:143]
    ds_read_b64_tr_b16 v[24:25], v4 offset:128
    ds_read_b64_tr_b16 v[26:27], v4 offset:3200
    s_waitcnt lgkmcnt(6)
    v_mfma_f32_32x32x16_bf16 v[144:159], v[36:39], v[44:47], v[144:159]
    s_barrier
    ds_read_b64_tr_b16 v[28:29], v5 offset:192
    ds_read_b64_tr_b16 v[30:31], v5 offset:3264
    s_waitcnt lgkmcnt(6)
    v_mfma_f32_32x32x16_bf16 v[64:79], v[16:19], v[48:51], v[64:79]
    s_add_u32 s22, s22, 20480
    s_cmp_ge_u32 s22, 143360
    ds_read_b64_tr_b16 v[32:33], v4 offset:256
    ds_read_b64_tr_b16 v[34:35], v4 offset:3328
    s_waitcnt lgkmcnt(6)
    v_mfma_f32_32x32x16_bf16 v[80:95], v[20:23], v[48:51], v[80:95]
    s_cselect_b32 s22, 0, s22
    v_add_u32 v6, s22, v10
    ds_read_b64_tr_b16 v[36:37], v5 offset:320
    ds_read_b64_tr_b16 v[38:39], v5 offset:3392
    s_waitcnt lgkmcnt(6)
    v_mfma_f32_32x32x16_bf16 v[96:111], v[24:27], v[48:51], v[96:111]
    ds_read_b64_tr_b16 v[16:17], v4 offset:6144
    ds_read_b64_tr_b16 v[18:19], v4 offset:9216
    ds_read_b128 v[40:43], v6 offset:0
    s_waitcnt lgkmcnt(7)
    v_mfma_f32_32x32x16_bf16 v[112:127], v[28:31], v[48:51], v[112:127]
    ds_read_b64_tr_b16 v[20:21], v5 offset:6208
    ds_read_b64_tr_b16 v[22:23], v5 offset:9280
    ds_read_b128 v[44:47], v6 offset:1024
    s_waitcnt lgkmcnt(8)
    v_mfma_f32_32x32x16_bf16 v[128:143], v[32:35], v[48:51], v[128:143]
    ds_read_b64_tr_b16 v[24:25], v4 offset:6272
    ds_read_b64_tr_b16 v[26:27], v4 offset:9344
    s_waitcnt lgkmcnt(8)
    v_mfma_f32_32x32x16_bf16 v[144:159], v[36:39], v[48:51], v[144:159]
    ds_read_b64_tr_b16 v[28:29], v5 offset:6336
    ds_read_b64_tr_b16 v[30:31], v5 offset:9408
    s_waitcnt lgkmcnt(8)
    v_mfma_f32_32x32x16_bf16 v[64:79], v[16:19], v[52:55], v[64:79]
    ds_read_b64_tr_b16 v[32:33], v4 offset:6400
    ds_read_b64_tr_b16 v[34:35], v4 offset:9472
    s_waitcnt lgkmcnt(7)
    v_mfma_f32_32x32x16_bf16 v[80:95], v[20:23], v[52:55], v[80:95]
    ds_read_b64_tr_b16 v[36:37], v5 offset:6464
    ds_read_b64_tr_b16 v[38:39], v5 offset:9536
    v_add_u32 v4, s22, v8
    s_waitcnt lgkmcnt(6)
    v_mfma_f32_32x32x16_bf16 v[96:111], v[24:27], v[52:55], v[96:111]
    v_add_u32 v5, s22, v9
    ds_read_b64_tr_b16 v[16:17], v4 offset:0
    ds_read_b64_tr_b16 v[18:19], v4 offset:3072
    s_waitcnt lgkmcnt(6)
    v_mfma_f32_32x32x16_bf16 v[112:127], v[28:31], v[52:55], v[112:127]
    ds_read_b64_tr_b16 v[20:21], v5 offset:64
    ds_read_b64_tr_b16 v[22:23], v5 offset:3136
    s_waitcnt lgkmcnt(6)
    v_mfma_f32_32x32x16_bf16 v[128:143], v[32:35], v[52:55], v[128:143]
    ds_read_b64_tr_b16 v[24:25], v4 offset:128
    ds_read_b64_tr_b16 v[26:27], v4 offset:3200
    s_waitcnt lgkmcnt(6)
    v_mfma_f32_32x32x16_bf16 v[144:159], v[36:39], v[52:55], v[144:159]
    s_barrier
    ds_read_b64_tr_b16 v[28:29], v5 offset:192
    ds_read_b64_tr_b16 v[30:31], v5 offset:3264
    s_waitcnt lgkmcnt(6)
    v_mfma_f32_32x32x16_bf16 v[64:79], v[16:19], v[40:43], v[64:79]
    s_add_u32 s22, s22, 20480
    s_cmp_ge_u32 s22, 143360
    ds_read_b64_tr_b16 v[32:33], v4 offset:256
    ds_read_b64_tr_b16 v[34:35], v4 offset:3328
    s_waitcnt lgkmcnt(6)
    v_mfma_f32_32x32x16_bf16 v[80:95], v[20:23], v[40:43], v[80:95]
    s_cselect_b32 s22, 0, s22
    v_add_u32 v6, s22, v10
    ds_read_b64_tr_b16 v[36:37], v5 offset:320
    ds_read_b64_tr_b16 v[38:39], v5 offset:3392
    s_waitcnt lgkmcnt(6)
    v_mfma_f32_32x32x16_bf16 v[96:111], v[24:27], v[40:43], v[96:111]
    ds_read_b64_tr_b16 v[16:17], v4 offset:6144
    ds_read_b64_tr_b16 v[18:19], v4 offset:9216
    ds_read_b128 v[48:51], v6 offset:0
    s_waitcnt lgkmcnt(7)
    v_mfma_f32_32x32x16_bf16 v[112:127], v[28:31], v[40:43], v[112:127]
    ds_read_b64_tr_b16 v[20:21], v5 offset:6208
    ds_read_b64_tr_b16 v[22:23], v5 offset:9280
    ds_read_b128 v[52:55], v6 offset:1024
    s_waitcnt lgkmcnt(8)
    v_mfma_f32_32x32x16_bf16 v[128:143], v[32:35], v[40:43], v[128:143]
    ds_read_b64_tr_b16 v[24:25], v4 offset:6272
    ds_read_b64_tr_b16 v[26:27], v4 offset:9344
    s_waitcnt lgkmcnt(8)
    v_mfma_f32_32x32x16_bf16 v[144:159], v[36:39], v[40:43], v[144:159]
    ds_read_b64_tr_b16 v[28:29], v5 offset:6336
    ds_read_b64_tr_b16 v[30:31], v5 offset:9408
    s_waitcnt lgkmcnt(8)
    v_mfma_f32_32x32x16_bf16 v[64:79], v[16:19], v[44:47], v[64:79]
    ds_read_b64_tr_b16 v[32:33], v4 offset:6400
    ds_read_b64_tr_b16 v[34:35], v4 offset:9472
    s_waitcnt lgkmcnt(7)
    v_mfma_f32_32x32x16_bf16 v[80:95], v[20:23], v[44:47], v[80:95]
    ds_read_b64_tr_b16 v[36:37], v5 offset:6464
    ds_read_b64_tr_b16 v[38:39], v5 offset:9536
    v_add_u32 v4, s22, v8
    s_waitcnt lgkmcnt(6)
    v_mfma_f32_32x32x16_bf16 v[96:111], v[24:27], v[44:47], v[96:111]
    v_add_u32 v5, s22, v9
    ds_read_b64_tr_b16 v[16:17], v4 offset:0
    ds_read_b64_tr_b16 v[18:19], v4 offset:3072
    s_waitcnt lgkmcnt(6)
    v_mfma_f32_32x32x16_bf16 v[112:127], v[28:31], v[44:47], v[112:127]
    ds_read_b64_tr_b16 v[20:21], v5 offset:64
    ds_read_b64_tr_b16 v[22:23], v5 offset:3136
    s_waitcnt lgkmcnt(6)
    v_mfma_f32_32x32x16_bf16 v[128:143], v[32:35], v[44:47], v[128:143]
    ds_read_b64_tr_b16 v[24:25], v4 offset:128
    ds_read_b64_tr_b16 v[26:27], v4 offset:3200
    s_waitcnt lgkmcnt(6)
    v_mfma_f32_32x32x16_bf16 v[144:159], v[36:39], v[44:47], v[144:159]
    s_barrier
    ds_read_b64_tr_b16 v[28:29], v5 offset:192
    ds_read_b64_tr_b16 v[30:31], v5 offset:3264
    s_waitcnt lgkmcnt(6)
    v_mfma_f32_32x32x16_bf16 v[64:79], v[16:19], v[48:51], v[64:79]
    s_add_u32 s22, s22, 20480
    s_cmp_ge_u32 s22, 143360
    ds_read_b64_tr_b16 v[32:33], v4 offset:256
    ds_read_b64_tr_b16 v[34:35], v4 offset:3328
    s_waitcnt lgkmcnt(6)
    v_mfma_f32_32x32x16_bf16 v[80:95], v[20:23], v[48:51], v[80:95]
    s_cselect_b32 s22, 0, s22
    v_add_u32 v6, s22, v10
    ds_read_b64_tr_b16 v[36:37], v5 offset:320
    ds_read_b64_tr_b16 v[38:39], v5 offset:3392
    s_waitcnt lgkmcnt(6)
    v_mfma_f32_32x32x16_bf16 v[96:111], v[24:27], v[48:51], v[96:111]
    ds_read_b64_tr_b16 v[16:17], v4 offset:6144
    ds_read_b64_tr_b16 v[18:19], v4 offset:9216
    ds_read_b128 v[40:43], v6 offset:0
    s_waitcnt lgkmcnt(7)
    v_mfma_f32_32x32x16_bf16 v[112:127], v[28:31], v[48:51], v[112:127]
    ds_read_b64_tr_b16 v[20:21], v5 offset:6208
    ds_read_b64_tr_b16 v[22:23], v5 offset:9280
    ds_read_b128 v[44:47], v6 offset:1024
    s_waitcnt lgkmcnt(8)
    v_mfma_f32_32x32x16_bf16 v[128:143], v[32:35], v[48:51], v[128:143]
    ds_read_b64_tr_b16 v[24:25], v4 offset:6272
    ds_read_b64_tr_b16 v[26:27], v4 offset:9344
    s_waitcnt lgkmcnt(8)
    v_mfma_f32_32x32x16_bf16 v[144:159], v[36:39], v[48:51], v[144:159]
    ds_read_b64_tr_b16 v[28:29], v5 offset:6336
    ds_read_b64_tr_b16 v[30:31], v5 offset:9408
    s_waitcnt lgkmcnt(8)
    v_mfma_f32_32x32x16_bf16 v[64:79], v[16:19], v[52:55], v[64:79]
    ds_read_b64_tr_b16 v[32:33], v4 offset:6400
    ds_read_b64_tr_b16 v[34:35], v4 offset:9472
    s_waitcnt lgkmcnt(7)
    v_mfma_f32_32x32x16_bf16 v[80:95], v[20:23], v[52:55], v[80:95]
    ds_read_b64_tr_b16 v[36:37], v5 offset:6464
    ds_read_b64_tr_b16 v[38:39], v5 offset:9536
    v_add_u32 v4, s22, v8
    s_waitcnt lgkmcnt(6)
    v_mfma_f32_32x32x16_bf16 v[96:111], v[24:27], v[52:55], v[96:111]
    v_add_u32 v5, s22, v9
    ds_read_b64_tr_b16 v[16:17], v4 offset:0
    ds_read_b64_tr_b16 v[18:19], v4 offset:3072
    s_waitcnt lgkmcnt(6)
    v_mfma_f32_32x32x16_bf16 v[112:127], v[28:31], v[52:55], v[112:127]
    ds_read_b64_tr_b16 v[20:21], v5 offset:64
    ds_read_b64_tr_b16 v[22:23], v5 offset:3136
    s_waitcnt lgkmcnt(6)
    v_mfma_f32_32x32x16_bf16 v[128:143], v[32:35], v[52:55], v[128:143]
    ds_read_b64_tr_b16 v[24:25], v4 offset:128
    ds_read_b64_tr_b16 v[26:27], v4 offset:3200
    s_waitcnt lgkmcnt(6)
    v_mfma_f32_32x32x16_bf16 v[144:159], v[36:39], v[52:55], v[144:159]
    s_barrier
    ds_read_b64_tr_b16 v[28:29], v5 offset:192
    ds_read_b64_tr_b16 v[30:31], v5 offset:3264
    s_add_u32 s25, s25, 4
    s_cmp_lt_u32 s25, 32
    s_cbranch_scc1 gated_mix__ssm_conv_h3__dense_activation_gelu__prompt_kernel_cloop
    s_waitcnt lgkmcnt(6)
    v_mfma_f32_32x32x16_bf16 v[64:79], v[16:19], v[40:43], v[64:79]
    s_add_u32 s22, s22, 20480
    s_cmp_ge_u32 s22, 143360
    ds_read_b64_tr_b16 v[32:33], v4 offset:256
    ds_read_b64_tr_b16 v[34:35], v4 offset:3328
    s_waitcnt lgkmcnt(6)
    v_mfma_f32_32x32x16_bf16 v[80:95], v[20:23], v[40:43], v[80:95]
    s_cselect_b32 s22, 0, s22
    v_add_u32 v6, s22, v10
    ds_read_b64_tr_b16 v[36:37], v5 offset:320
    ds_read_b64_tr_b16 v[38:39], v5 offset:3392
    s_waitcnt lgkmcnt(6)
    v_mfma_f32_32x32x16_bf16 v[96:111], v[24:27], v[40:43], v[96:111]
    ds_read_b64_tr_b16 v[16:17], v4 offset:6144
    ds_read_b64_tr_b16 v[18:19], v4 offset:9216
    ds_read_b128 v[48:51], v6 offset:0
    s_waitcnt lgkmcnt(7)
    v_mfma_f32_32x32x16_bf16 v[112:127], v[28:31], v[40:43], v[112:127]
    ds_read_b64_tr_b16 v[20:21], v5 offset:6208
    ds_read_b64_tr_b16 v[22:23], v5 offset:9280
    ds_read_b128 v[52:55], v6 offset:1024
    s_waitcnt lgkmcnt(8)
    v_mfma_f32_32x32x16_bf16 v[128:143], v[32:35], v[40:43], v[128:143]
    ds_read_b64_tr_b16 v[24:25], v4 offset:6272
    ds_read_b64_tr_b16 v[26:27], v4 offset:9344
    s_waitcnt lgkmcnt(8)
    v_mfma_f32_32x32x16_bf16 v[144:159], v[36:39], v[40:43], v[144:159]
    ds_read_b64_tr_b16 v[28:29], v5 offset:6336
    ds_read_b64_tr_b16 v[30:31], v5 offset:9408
    s_waitcnt lgkmcnt(8)
    v_mfma_f32_32x32x16_bf16 v[64:79], v[16:19], v[44:47], v[64:79]
    ds_read_b64_tr_b16 v[32:33], v4 offset:6400
    ds_read_b64_tr_b16 v[34:35], v4 offset:9472
    s_waitcnt lgkmcnt(7)
    v_mfma_f32_32x32x16_bf16 v[80:95], v[20:23], v[44:47], v[80:95]
    ds_read_b64_tr_b16 v[36:37], v5 offset:6464
    ds_read_b64_tr_b16 v[38:39], v5 offset:9536
    v_add_u32 v4, s22, v8
    s_waitcnt lgkmcnt(6)
    v_mfma_f32_32x32x16_bf16 v[96:111], v[24:27], v[44:47], v[96:111]
    v_add_u32 v5, s22, v9
    ds_read_b64_tr_b16 v[16:17], v4 offset:0
    ds_read_b64_tr_b16 v[18:19], v4 offset:3072
    s_waitcnt lgkmcnt(6)
    v_mfma_f32_32x32x16_bf16 v[112:127], v[28:31], v[44:47], v[112:127]
    ds_read_b64_tr_b16 v[20:21], v5 offset:64
    ds_read_b64_tr_b16 v[22:23], v5 offset:3136
    s_waitcnt lgkmcnt(6)
    v_mfma_f32_32x32x16_bf16 v[128:143], v[32:35], v[44:47], v[128:143]
    ds_read_b64_tr_b16 v[24:25], v4 offset:128
    ds_read_b64_tr_b16 v[26:27], v4 offset:3200
    s_waitcnt lgkmcnt(6)
    v_mfma_f32_32x32x16_bf16 v[144:159], v[36:39], v[44:47], v[144:159]
    s_barrier
    ds_read_b64_tr_b16 v[28:29], v5 offset:192
    ds_read_b64_tr_b16 v[30:31], v5 offset:3264
    s_waitcnt lgkmcnt(6)
    v_mfma_f32_32x32x16_bf16 v[64:79], v[16:19], v[48:51], v[64:79]
    s_add_u32 s22, s22, 20480
    s_cmp_ge_u32 s22, 143360
    ds_read_b64_tr_b16 v[32:33], v4 offset:256
    ds_read_b64_tr_b16 v[34:35], v4 offset:3328
    s_waitcnt lgkmcnt(6)
    v_mfma_f32_32x32x16_bf16 v[80:95], v[20:23], v[48:51], v[80:95]
    s_cselect_b32 s22, 0, s22
    v_add_u32 v6, s22, v10
    ds_read_b64_tr_b16 v[36:37], v5 offset:320
    ds_read_b64_tr_b16 v[38:39], v5 offset:3392
    s_waitcnt lgkmcnt(6)
    v_mfma_f32_32x32x16_bf16 v[96:111], v[24:27], v[48:51], v[96:111]
    ds_read_b64_tr_b16 v[16:17], v4 offset:6144
    ds_read_b64_tr_b16 v[18:19], v4 offset:9216
    ds_read_b128 v[40:43], v6 offset:0
    s_waitcnt lgkmcnt(7)
    v_mfma_f32_32x32x16_bf16 v[112:127], v[28:31], v[48:51], v[112:127]
    ds_read_b64_tr_b16 v[20:21], v5 offset:6208
    ds_read_b64_tr_b16 v[22:23], v5 offset:9280
    ds_read_b128 v[44:47], v6 offset:1024
    s_waitcnt lgkmcnt(8)
    v_mfma_f32_32x32x16_bf16 v[128:143], v[32:35], v[48:51], v[128:143]
    ds_read_b64_tr_b16 v[24:25], v4 offset:6272
    ds_read_b64_tr_b16 v[26:27], v4 offset:9344
    s_waitcnt lgkmcnt(8)
    v_mfma_f32_32x32x16_bf16 v[144:159], v[36:39], v[48:51], v[144:159]
    ds_read_b64_tr_b16 v[28:29], v5 offset:6336
    ds_read_b64_tr_b16 v[30:31], v5 offset:9408
    s_waitcnt lgkmcnt(8)
    v_mfma_f32_32x32x16_bf16 v[64:79], v[16:19], v[52:55], v[64:79]
    ds_read_b64_tr_b16 v[32:33], v4 offset:6400
    ds_read_b64_tr_b16 v[34:35], v4 offset:9472
    s_waitcnt lgkmcnt(7)
    v_mfma_f32_32x32x16_bf16 v[80:95], v[20:23], v[52:55], v[80:95]
    ds_read_b64_tr_b16 v[36:37], v5 offset:6464
    ds_read_b64_tr_b16 v[38:39], v5 offset:9536
    v_add_u32 v4, s22, v8
    s_waitcnt lgkmcnt(6)
    v_mfma_f32_32x32x16_bf16 v[96:111], v[24:27], v[52:55], v[96:111]
    v_add_u32 v5, s22, v9
    ds_read_b64_tr_b16 v[16:17], v4 offset:0
    ds_read_b64_tr_b16 v[18:19], v4 offset:3072
    s_waitcnt lgkmcnt(6)
    v_mfma_f32_32x32x16_bf16 v[112:127], v[28:31], v[52:55], v[112:127]
    ds_read_b64_tr_b16 v[20:21], v5 offset:64
    ds_read_b64_tr_b16 v[22:23], v5 offset:3136
    s_waitcnt lgkmcnt(6)
    v_mfma_f32_32x32x16_bf16 v[128:143], v[32:35], v[52:55], v[128:143]
    ds_read_b64_tr_b16 v[24:25], v4 offset:128
    ds_read_b64_tr_b16 v[26:27], v4 offset:3200
    s_waitcnt lgkmcnt(6)
    v_mfma_f32_32x32x16_bf16 v[144:159], v[36:39], v[52:55], v[144:159]
    s_barrier
    ds_read_b64_tr_b16 v[28:29], v5 offset:192
    ds_read_b64_tr_b16 v[30:31], v5 offset:3264
    s_waitcnt lgkmcnt(6)
    v_mfma_f32_32x32x16_bf16 v[64:79], v[16:19], v[40:43], v[64:79]
    s_add_u32 s22, s22, 20480
    s_cmp_ge_u32 s22, 143360
    ds_read_b64_tr_b16 v[32:33], v4 offset:256
    ds_read_b64_tr_b16 v[34:35], v4 offset:3328
    s_waitcnt lgkmcnt(6)
    v_mfma_f32_32x32x16_bf16 v[80:95], v[20:23], v[40:43], v[80:95]
    s_cselect_b32 s22, 0, s22
    v_add_u32 v6, s22, v10
    ds_read_b64_tr_b16 v[36:37], v5 offset:320
    ds_read_b64_tr_b16 v[38:39], v5 offset:3392
    s_waitcnt lgkmcnt(6)
    v_mfma_f32_32x32x16_bf16 v[96:111], v[24:27], v[40:43], v[96:111]
    ds_read_b64_tr_b16 v[16:17], v4 offset:6144
    ds_read_b64_tr_b16 v[18:19], v4 offset:9216
    ds_read_b128 v[48:51], v6 offset:0
    s_waitcnt lgkmcnt(7)
    v_mfma_f32_32x32x16_bf16 v[112:127], v[28:31], v[40:43], v[112:127]
    ds_read_b64_tr_b16 v[20:21], v5 offset:6208
    ds_read_b64_tr_b16 v[22:23], v5 offset:9280
    ds_read_b128 v[52:55], v6 offset:1024
    s_waitcnt lgkmcnt(8)
    v_mfma_f32_32x32x16_bf16 v[128:143], v[32:35], v[40:43], v[128:143]
    ds_read_b64_tr_b16 v[24:25], v4 offset:6272
    ds_read_b64_tr_b16 v[26:27], v4 offset:9344
    s_waitcnt lgkmcnt(8)
    v_mfma_f32_32x32x16_bf16 v[144:159], v[36:39], v[40:43], v[144:159]
    ds_read_b64_tr_b16 v[28:29], v5 offset:6336
    ds_read_b64_tr_b16 v[30:31], v5 offset:9408
    s_waitcnt lgkmcnt(8)
    v_mfma_f32_32x32x16_bf16 v[64:79], v[16:19], v[44:47], v[64:79]
    ds_read_b64_tr_b16 v[32:33], v4 offset:6400
    ds_read_b64_tr_b16 v[34:35], v4 offset:9472
    s_waitcnt lgkmcnt(7)
    v_mfma_f32_32x32x16_bf16 v[80:95], v[20:23], v[44:47], v[80:95]
    ds_read_b64_tr_b16 v[36:37], v5 offset:6464
    ds_read_b64_tr_b16 v[38:39], v5 offset:9536
    v_add_u32 v4, s22, v8
    s_waitcnt lgkmcnt(6)
    v_mfma_f32_32x32x16_bf16 v[96:111], v[24:27], v[44:47], v[96:111]
    v_add_u32 v5, s22, v9
    ds_read_b64_tr_b16 v[16:17], v4 offset:0
    ds_read_b64_tr_b16 v[18:19], v4 offset:3072
    s_waitcnt lgkmcnt(6)
    v_mfma_f32_32x32x16_bf16 v[112:127], v[28:31], v[44:47], v[112:127]
    ds_read_b64_tr_b16 v[20:21], v5 offset:64
    ds_read_b64_tr_b16 v[22:23], v5 offset:3136
    s_waitcnt lgkmcnt(6)
    v_mfma_f32_32x32x16_bf16 v[128:143], v[32:35], v[44:47], v[128:143]
    ds_read_b64_tr_b16 v[24:25], v4 offset:128
    ds_read_b64_tr_b16 v[26:27], v4 offset:3200
    s_waitcnt lgkmcnt(6)
    v_mfma_f32_32x32x16_bf16 v[144:159], v[36:39], v[44:47], v[144:159]
    s_barrier
    ds_read_b64_tr_b16 v[28:29], v5 offset:192
    ds_read_b64_tr_b16 v[30:31], v5 offset:3264
    s_waitcnt lgkmcnt(6)
    v_mfma_f32_32x32x16_bf16 v[64:79], v[16:19], v[48:51], v[64:79]
    ds_read_b64_tr_b16 v[32:33], v4 offset:256
    ds_read_b64_tr_b16 v[34:35], v4 offset:3328
    s_waitcnt lgkmcnt(6)
    v_mfma_f32_32x32x16_bf16 v[80:95], v[20:23], v[48:51], v[80:95]
    ds_read_b64_tr_b16 v[36:37], v5 offset:320
    ds_read_b64_tr_b16 v[38:39], v5 offset:3392
    s_waitcnt lgkmcnt(6)
    v_mfma_f32_32x32x16_bf16 v[96:111], v[24:27], v[48:51], v[96:111]
    ds_read_b64_tr_b16 v[16:17], v4 offset:6144
    ds_read_b64_tr_b16 v[18:19], v4 offset:9216
    s_waitcnt lgkmcnt(6)
    v_mfma_f32_32x32x16_bf16 v[112:127], v[28:31], v[48:51], v[112:127]
    ds_read_b64_tr_b16 v[20:21], v5 offset:6208
    ds_read_b64_tr_b16 v[22:23], v5 offset:9280
    s_waitcnt lgkmcnt(6)
    v_mfma_f32_32x32x16_bf16 v[128:143], v[32:35], v[48:51], v[128:143]
    ds_read_b64_tr_b16 v[24:25], v4 offset:6272
    ds_read_b64_tr_b16 v[26:27], v4 offset:9344
    s_waitcnt lgkmcnt(6)
    v_mfma_f32_32x32x16_bf16 v[144:159], v[36:39], v[48:51], v[144:159]
    ds_read_b64_tr_b16 v[28:29], v5 offset:6336
    ds_read_b64_tr_b16 v[30:31], v5 offset:9408
    s_waitcnt lgkmcnt(6)
    v_mfma_f32_32x32x16_bf16 v[64:79], v[16:19], v[52:55], v[64:79]
    ds_read_b64_tr_b16 v[32:33], v4 offset:6400
    ds_read_b64_tr_b16 v[34:35], v4 offset:9472
    s_waitcnt lgkmcnt(6)
    v_mfma_f32_32x32x16_bf16 v[80:95], v[20:23], v[52:55], v[80:95]
    ds_read_b64_tr_b16 v[36:37], v5 offset:6464
    ds_read_b64_tr_b16 v[38:39], v5 offset:9536
    s_waitcnt lgkmcnt(6)
    v_mfma_f32_32x32x16_bf16 v[96:111], v[24:27], v[52:55], v[96:111]
    s_waitcnt lgkmcnt(4)
    v_mfma_f32_32x32x16_bf16 v[112:127], v[28:31], v[52:55], v[112:127]
    s_waitcnt lgkmcnt(2)
    v_mfma_f32_32x32x16_bf16 v[128:143], v[32:35], v[52:55], v[128:143]
    s_waitcnt lgkmcnt(0)
    v_mfma_f32_32x32x16_bf16 v[144:159], v[36:39], v[52:55], v[144:159]
    s_barrier
    s_nop 7
    s_nop 3
    v_lshlrev_b32 v3, 4, v1
    s_cmp_eq_u32 s20, s18
    s_cbranch_scc1 gated_mix__ssm_conv_h3__dense_activation_gelu__prompt_kernel_keep
    s_lshl_b32 s33, s18, 4
    s_add_u32 s33, s33, s16
    s_lshl_b32 s33, s33, 2
    s_add_u32 s33, s33, s20
    s_mul_i32 s33, s33, 18
    s_mul_i32 s34, s17, 6
    s_add_u32 s33, s33, s34
    s_lshl_b32 s33, s33, 11
    s_add_u32 s33, s33, 24117248

    v_cvt_pk_bf16_f32 v16, v64, v65
    v_cvt_pk_bf16_f32 v17, v66, v67
    v_cvt_pk_bf16_f32 v18, v68, v69
    v_cvt_pk_bf16_f32 v19, v70, v71
    v_cvt_pk_bf16_f32 v20, v72, v73
    v_cvt_pk_bf16_f32 v21, v74, v75
    v_cvt_pk_bf16_f32 v22, v76, v77
    v_cvt_pk_bf16_f32 v23, v78, v79
    buffer_store_dwordx4 v[16:19], v3, s[8:11], s33 offen sc1
    buffer_store_dwordx4 v[20:23], v3, s[8:11], s33 offen offset:1024 sc1
    v_cvt_pk_bf16_f32 v24, v80, v81
    v_cvt_pk_bf16_f32 v25, v82, v83
    v_cvt_pk_bf16_f32 v26, v84, v85
    v_cvt_pk_bf16_f32 v27, v86, v87
    v_cvt_pk_bf16_f32 v28, v88, v89
    v_cvt_pk_bf16_f32 v29, v90, v91
    v_cvt_pk_bf16_f32 v30, v92, v93
    v_cvt_pk_bf16_f32 v31, v94, v95
    s_add_u32 s33, s33, 2048
    buffer_store_dwordx4 v[24:27], v3, s[8:11], s33 offen sc1
    buffer_store_dwordx4 v[28:31], v3, s[8:11], s33 offen offset:1024 sc1
    v_cvt_pk_bf16_f32 v16, v96, v97
    v_cvt_pk_bf16_f32 v17, v98, v99
    v_cvt_pk_bf16_f32 v18, v100, v101
    v_cvt_pk_bf16_f32 v19, v102, v103
    v_cvt_pk_bf16_f32 v20, v104, v105
    v_cvt_pk_bf16_f32 v21, v106, v107
    v_cvt_pk_bf16_f32 v22, v108, v109
    v_cvt_pk_bf16_f32 v23, v110, v111
    s_add_u32 s33, s33, 2048
    buffer_store_dwordx4 v[16:19], v3, s[8:11], s33 offen sc1
    buffer_store_dwordx4 v[20:23], v3, s[8:11], s33 offen offset:1024 sc1
    v_cvt_pk_bf16_f32 v24, v112, v113
    v_cvt_pk_bf16_f32 v25, v114, v115
    v_cvt_pk_bf16_f32 v26, v116, v117
    v_cvt_pk_bf16_f32 v27, v118, v119
    v_cvt_pk_bf16_f32 v28, v120, v121
    v_cvt_pk_bf16_f32 v29, v122, v123
    v_cvt_pk_bf16_f32 v30, v124, v125
    v_cvt_pk_bf16_f32 v31, v126, v127
    s_add_u32 s33, s33, 2048
    buffer_store_dwordx4 v[24:27], v3, s[8:11], s33 offen sc1
    buffer_store_dwordx4 v[28:31], v3, s[8:11], s33 offen offset:1024 sc1
    v_cvt_pk_bf16_f32 v16, v128, v129
    v_cvt_pk_bf16_f32 v17, v130, v131
    v_cvt_pk_bf16_f32 v18, v132, v133
    v_cvt_pk_bf16_f32 v19, v134, v135
    v_cvt_pk_bf16_f32 v20, v136, v137
    v_cvt_pk_bf16_f32 v21, v138, v139
    v_cvt_pk_bf16_f32 v22, v140, v141
    v_cvt_pk_bf16_f32 v23, v142, v143
    s_add_u32 s33, s33, 2048
    buffer_store_dwordx4 v[16:19], v3, s[8:11], s33 offen sc1
    buffer_store_dwordx4 v[20:23], v3, s[8:11], s33 offen offset:1024 sc1
    v_cvt_pk_bf16_f32 v24, v144, v145
    v_cvt_pk_bf16_f32 v25, v146, v147
    v_cvt_pk_bf16_f32 v26, v148, v149
    v_cvt_pk_bf16_f32 v27, v150, v151
    v_cvt_pk_bf16_f32 v28, v152, v153
    v_cvt_pk_bf16_f32 v29, v154, v155
    v_cvt_pk_bf16_f32 v30, v156, v157
    v_cvt_pk_bf16_f32 v31, v158, v159
    s_add_u32 s33, s33, 2048
    buffer_store_dwordx4 v[24:27], v3, s[8:11], s33 offen sc1
    buffer_store_dwordx4 v[28:31], v3, s[8:11], s33 offen offset:1024 sc1
    s_mul_i32 s40, s16, 3
    s_add_u32 s40, s40, s17
    s_lshl_b32 s40, s40, 2
    s_add_u32 s40, s40, s18
    s_lshl_b32 s40, s40, 2
    s_add_u32 s40, s40, s20
    s_add_u32 s40, s40, 912
    s_mov_b32 s41, 0
    s_branch gated_mix__ssm_conv_h3__dense_activation_gelu__prompt_kernel_exp_done

gated_mix__ssm_conv_h3__dense_activation_gelu__prompt_kernel_keep:
    ds_write_b128 v3, v[64:67] offset:0
    ds_write_b128 v3, v[68:71] offset:1024
    ds_write_b128 v3, v[72:75] offset:2048
    ds_write_b128 v3, v[76:79] offset:3072
    ds_write_b128 v3, v[80:83] offset:4096
    ds_write_b128 v3, v[84:87] offset:5120
    ds_write_b128 v3, v[88:91] offset:6144
    ds_write_b128 v3, v[92:95] offset:7168
    ds_write_b128 v3, v[96:99] offset:8192
    ds_write_b128 v3, v[100:103] offset:9216
    ds_write_b128 v3, v[104:107] offset:10240
    ds_write_b128 v3, v[108:111] offset:11264
    ds_write_b128 v3, v[112:115] offset:12288
    ds_write_b128 v3, v[116:119] offset:13312
    ds_write_b128 v3, v[120:123] offset:14336
    ds_write_b128 v3, v[124:127] offset:15360
    ds_write_b128 v3, v[128:131] offset:16384
    ds_write_b128 v3, v[132:135] offset:17408
    ds_write_b128 v3, v[136:139] offset:18432
    ds_write_b128 v3, v[140:143] offset:19456
    ds_write_b128 v3, v[144:147] offset:20480
    ds_write_b128 v3, v[148:151] offset:21504
    ds_write_b128 v3, v[152:155] offset:22528
    ds_write_b128 v3, v[156:159] offset:23552
    s_mul_i32 s40, s16, 3
    s_add_u32 s40, s40, s17
    s_lshl_b32 s40, s40, 4
    s_add_u32 s40, s40, s18
    s_add_u32 s40, s40, 912
    s_mov_b32 s41, 1
    s_branch gated_mix__ssm_conv_h3__dense_activation_gelu__prompt_kernel_exp_done

gated_mix__ssm_conv_h3__dense_activation_gelu__prompt_kernel_prod:
    s_waitcnt vmcnt(20)
    s_barrier
    s_mov_b32 s25, 1
gated_mix__ssm_conv_h3__dense_activation_gelu__prompt_kernel_ploop:
    s_cmp_eq_u32 s25, 11
    s_cbranch_scc0 gated_mix__ssm_conv_h3__dense_activation_gelu__prompt_kernel_nopoll2
    s_lshl_b32 s33, s16, 4
    s_lshl_b32 s34, s18, 2
    s_add_u32 s33, s33, s34
    s_add_u32 s33, s33, 208
    v_add_u32 v16, s33, v1
    v_lshlrev_b32 v16, 6, v16
    v_cmp_gt_u32 vcc, 4, v1
    v_mov_b32 v17, 0
    v_mov_b32 v18, 5
    s_nop 0
    v_cndmask_b32 v17, v17, v18, vcc

    s_mov_b32 s33, 0
    Lfp3:
    buffer_load_dwordx2 v[18:19], v16, s[92:95], 0 offen sc1
    s_waitcnt vmcnt(0)
    v_subrev_u32 v18, s96, v18
    v_cmp_eq_u32 vcc, s97, v19
    v_cmp_ge_u32 s[34:35], v18, v17
    s_and_b64 vcc, vcc, s[34:35]
    v_cmp_gt_u32 s[34:35], 16, v18
    s_and_b64 vcc, vcc, s[34:35]
    v_cmp_eq_u32 s[34:35], 0, v17
    s_or_b64 vcc, vcc, s[34:35]
    s_add_u32 s33, s33, 1
    s_cmp_ge_u32 s33, 262144
    s_cbranch_scc1 Lfp3_d
    s_cmp_eq_u64 vcc, exec
    s_cbranch_scc1 Lfp3_d
    s_sleep 1
    s_branch Lfp3
    Lfp3_d:

gated_mix__ssm_conv_h3__dense_activation_gelu__prompt_kernel_nopoll2:
    s_and_b32 s56, s60, 63
    s_lshr_b32 s60, s60, 6
    s_add_u32 s57, s57, 1
    s_cmp_eq_u32 s57, 5
    s_cbranch_scc0 gated_mix__ssm_conv_h3__dense_activation_gelu__prompt_kernel_rot3651
    s_mov_b32 s60, s61
    s_mov_b32 s61, s62
    s_mov_b32 s62, s63
    s_mov_b32 s63, s64
    s_mov_b32 s64, s65
    s_mov_b32 s65, s66
    s_mov_b32 s66, s67
    s_mov_b32 s57, 0
gated_mix__ssm_conv_h3__dense_activation_gelu__prompt_kernel_rot3651:
    s_mul_i32 s34, s56, 36864
    s_add_u32 s34, s34, s52
    s_lshl_b32 s35, s56, 13
    s_add_u32 s35, s35, s53
    s_add_u32 s33, s22, s54
    s_add_u32 m0, s33, 0
    s_nop 0
    buffer_load_dwordx4 v10, s[4:7], s34 offen lds
    s_add_u32 s33, s22, s54
    s_add_u32 m0, s33, 1024
    s_nop 0
    buffer_load_dwordx4 v11, s[4:7], s34 offen lds
    s_add_u32 s33, s22, s54
    s_add_u32 m0, s33, 2048
    s_nop 0
    buffer_load_dwordx4 v12, s[4:7], s34 offen lds
    s_add_u32 s33, s22, s55
    s_add_u32 m0, s33, 0
    s_add_u32 s33, s35, 0
    buffer_load_dwordx4 v13, s[8:11], s33 offen sc1 lds
    s_add_u32 s33, s22, s55
    s_add_u32 m0, s33, 1024
    s_add_u32 s33, s35, 1024
    buffer_load_dwordx4 v13, s[8:11], s33 offen sc1 lds
    s_add_u32 s22, s22, 20480
    s_cmp_ge_u32 s22, 143360
    s_cselect_b32 s22, 0, s22
    s_waitcnt vmcnt(20)
    s_barrier
    s_add_u32 s25, s25, 1
    s_cmp_le_u32 s25, 30
    s_cbranch_scc1 gated_mix__ssm_conv_h3__dense_activation_gelu__prompt_kernel_ploop
    s_cmp_lg_u32 s98, 7
    s_cbranch_scc1 gated_mix__ssm_conv_h3__dense_activation_gelu__prompt_kernel_noA1
    s_mul_i32 s33, s17, 64
    s_mul_i32 s33, s33, 21846
    s_lshr_b32 s33, s33, 16
    s_add_u32 s33, s33, 136
    v_add_u32 v20, s33, v1
    v_mov_b32 v21, 0
    v_mov_b32 v18, 2
    v_cmp_le_u32 vcc, 8, v1
    v_cmp_gt_u32 s[34:35], 31, v1
    s_and_b64 vcc, vcc, s[34:35]
    v_mov_b32 v19, 207
    v_cmp_ge_u32 s[34:35], v19, v20
    s_and_b64 vcc, vcc, s[34:35]
    v_cndmask_b32 v21, v21, v18, vcc
    v_min_u32 v20, 1679, v20
    v_lshlrev_b32 v20, 6, v20
    buffer_load_dwordx2 v[22:23], v20, s[92:95], 0 offen sc1

gated_mix__ssm_conv_h3__dense_activation_gelu__prompt_kernel_noA1:
    s_load_dwordx2 s[44:45], s[0:1], 0
    s_load_dwordx2 s[48:49], s[0:1], 88
    s_lshl_b32 s33, s16, 7
    s_lshl_b32 s34, s18, 5
    s_add_u32 s33, s33, s34
    s_lshl_b32 s34, s20, 3
    s_add_u32 s33, s33, s34
    v_lshrrev_b32 v26, 3, v1
    v_add_u32 v27, s33, v26
    v_and_b32 v28, 7, v1
    s_movk_i32 s33, 1152
    v_mul_lo_u32 v27, v27, s33
    v_lshlrev_b32 v29, 4, v28
    v_add_u32 v27, v27, v29
    s_waitcnt lgkmcnt(0)
    s_mov_b32 s46, 2359296
    s_mov_b32 s47, 0x00020000
    s_mov_b32 s50, 1152
    s_mov_b32 s51, 0x00020000

    s_waitcnt vmcnt(15)
    s_barrier
    buffer_load_dwordx4 v[32:35], v27, s[44:47], 0 offen offset:0
    buffer_load_dwordx4 v[36:39], v27, s[44:47], 0 offen offset:128
    buffer_load_dwordx4 v[40:43], v27, s[44:47], 0 offen offset:256
    buffer_load_dwordx4 v[44:47], v27, s[44:47], 0 offen offset:384
    buffer_load_dwordx4 v[48:51], v27, s[44:47], 0 offen offset:512
    s_waitcnt vmcnt(15)
    s_barrier
    buffer_load_dwordx4 v[52:55], v27, s[44:47], 0 offen offset:640
    buffer_load_dwordx4 v[56:59], v27, s[44:47], 0 offen offset:768
    buffer_load_dwordx4 v[60:63], v27, s[44:47], 0 offen offset:896
    buffer_load_dwordx4 v[64:67], v27, s[44:47], 0 offen offset:1024
    buffer_load_dwordx4 v[68:71], v29, s[48:51], 0 offen offset:0
    s_waitcnt vmcnt(15)
    s_barrier
    buffer_load_dwordx4 v[72:75], v29, s[48:51], 0 offen offset:128
    buffer_load_dwordx4 v[76:79], v29, s[48:51], 0 offen offset:256
    buffer_load_dwordx4 v[80:83], v29, s[48:51], 0 offen offset:384
    buffer_load_dwordx4 v[84:87], v29, s[48:51], 0 offen offset:512
    s_waitcnt vmcnt(14)
    s_barrier
    buffer_load_dwordx4 v[88:91], v29, s[48:51], 0 offen offset:640
    buffer_load_dwordx4 v[92:95], v29, s[48:51], 0 offen offset:768
    buffer_load_dwordx4 v[96:99], v29, s[48:51], 0 offen offset:896
    buffer_load_dwordx4 v[100:103], v29, s[48:51], 0 offen offset:1024
    s_waitcnt vmcnt(18)
    s_barrier
    s_waitcnt vmcnt(0)
    v_mov_b32 v30, 0
    v_mov_b32 v31, 0
    v_dot2_f32_bf16 v30, v32, v68, v30
    v_dot2_f32_bf16 v31, v33, v69, v31
    v_dot2_f32_bf16 v30, v34, v70, v30
    v_dot2_f32_bf16 v31, v35, v71, v31
    v_dot2_f32_bf16 v30, v36, v72, v30
    v_dot2_f32_bf16 v31, v37, v73, v31
    v_dot2_f32_bf16 v30, v38, v74, v30
    v_dot2_f32_bf16 v31, v39, v75, v31
    v_dot2_f32_bf16 v30, v40, v76, v30
    v_dot2_f32_bf16 v31, v41, v77, v31
    v_dot2_f32_bf16 v30, v42, v78, v30
    v_dot2_f32_bf16 v31, v43, v79, v31
    v_dot2_f32_bf16 v30, v44, v80, v30
    v_dot2_f32_bf16 v31, v45, v81, v31
    v_dot2_f32_bf16 v30, v46, v82, v30
    v_dot2_f32_bf16 v31, v47, v83, v31
    v_dot2_f32_bf16 v30, v48, v84, v30
    v_dot2_f32_bf16 v31, v49, v85, v31
    v_dot2_f32_bf16 v30, v50, v86, v30
    v_dot2_f32_bf16 v31, v51, v87, v31
    v_dot2_f32_bf16 v30, v52, v88, v30
    v_dot2_f32_bf16 v31, v53, v89, v31
    v_dot2_f32_bf16 v30, v54, v90, v30
    v_dot2_f32_bf16 v31, v55, v91, v31
    v_dot2_f32_bf16 v30, v56, v92, v30
    v_dot2_f32_bf16 v31, v57, v93, v31
    v_dot2_f32_bf16 v30, v58, v94, v30
    v_dot2_f32_bf16 v31, v59, v95, v31
    v_dot2_f32_bf16 v30, v60, v96, v30
    v_dot2_f32_bf16 v31, v61, v97, v31
    v_dot2_f32_bf16 v30, v62, v98, v30
    v_dot2_f32_bf16 v31, v63, v99, v31
    v_dot2_f32_bf16 v30, v64, v100, v30
    v_dot2_f32_bf16 v31, v65, v101, v31
    v_dot2_f32_bf16 v30, v66, v102, v30
    v_dot2_f32_bf16 v31, v67, v103, v31
    s_nop 2
    v_add_f32 v30, v30, v31
    s_nop 1
    v_add_f32_dpp v30, v30, v30 quad_perm:[1,0,3,2] row_mask:0xf bank_mask:0xf
    s_nop 1
    v_add_f32_dpp v30, v30, v30 quad_perm:[2,3,0,1] row_mask:0xf bank_mask:0xf
    s_nop 1
    v_add_f32_dpp v30, v30, v30 row_half_mirror row_mask:0xf bank_mask:0xf
    v_cvt_pk_bf16_f32 v30, v30, v30
    v_lshlrev_b32 v30, 16, v30
    v_mul_f32 v30, 0xbfb8aa3b, v30
    v_exp_f32 v30, v30
    s_nop 0
    v_add_f32 v30, 1.0, v30
    v_rcp_f32 v30, v30
    s_nop 0
    v_cvt_pk_bf16_f32 v30, v30, v30
    v_lshlrev_b32 v30, 16, v30
    v_sub_f32 v31, 1.0, v30
    v_cvt_pk_bf16_f32 v31, v31, v31
    v_lshlrev_b32 v31, 16, v31
    s_lshl_b32 s33, s20, 6
    s_add_u32 s33, s33, 143360
    v_lshlrev_b32 v26, 3, v26
    v_add_u32 v26, s33, v26
    v_cmp_eq_u32 vcc, 0, v28
    s_and_saveexec_b64 s[30:31], vcc
    ds_write_b64 v26, v[30:31]
    s_mov_b64 exec, s[30:31]
    s_waitcnt lgkmcnt(0)

    s_barrier
    s_mul_i32 s17, s17, 6
    s_add_u32 s17, s17, s20
    s_mov_b32 s29, s20
    s_load_dwordx2 s[36:37], s[0:1], 0
    s_load_dwordx2 s[38:39], s[0:1], 80
    s_load_dwordx2 s[48:49], s[0:1], 96
    s_waitcnt lgkmcnt(0)
    s_mov_b32 s12, s48
    s_mov_b32 s13, s49
    s_mov_b32 s14, 2359296
    s_mov_b32 s15, 0x00020000
    s_mov_b32 s20, s36
    s_mov_b32 s21, s37
    s_mov_b32 s22, 2359296
    s_mov_b32 s23, 0x00020000
    s_mov_b32 s24, s38
    s_mov_b32 s25, s39
    s_mov_b32 s26, 1152
    s_mov_b32 s27, 0x00020000
    v_and_b32 v6, 31, v1
    v_lshrrev_b32 v7, 5, v1
    s_lshl_b32 s33, s16, 7
    s_lshl_b32 s34, s18, 5
    s_add_u32 s33, s33, s34
    v_add_u32 v8, s33, v6
    s_movk_i32 s34, 1152
    v_mul_lo_u32 v9, v8, s34
    v_lshlrev_b32 v10, 4, v7
    s_lshl_b32 s34, s17, 6
    v_add_u32 v10, s34, v10
    v_add_u32 v9, v9, v10
    buffer_load_dwordx4 v[96:99], v9, s[20:23], 0 offen
    buffer_load_dwordx4 v[100:103], v9, s[20:23], 0 offen offset:32
    buffer_load_dwordx4 v[104:107], v10, s[24:27], 0 offen
    buffer_load_dwordx4 v[108:111], v10, s[24:27], 0 offen offset:32

    s_cmp_lg_u32 s98, 7
    s_cbranch_scc1 gated_mix__ssm_conv_h3__dense_activation_gelu__prompt_kernel_noA2
    v_subrev_u32 v22, s96, v22
    v_cmp_eq_u32 vcc, s97, v23
    v_cmp_ge_u32 s[34:35], v22, v21
    s_and_b64 vcc, vcc, s[34:35]
    v_cmp_gt_u32 s[34:35], 16, v22
    s_and_b64 vcc, vcc, s[34:35]
    v_cmp_eq_u32 s[34:35], 0, v21
    s_or_b64 vcc, vcc, s[34:35]
    s_cmp_eq_u64 vcc, exec
    s_cbranch_scc1 Lfc4

    s_mov_b32 s33, 0
    Lfp5:
    buffer_load_dwordx2 v[24:25], v20, s[92:95], 0 offen sc1
    s_waitcnt vmcnt(0)
    v_subrev_u32 v24, s96, v24
    v_cmp_eq_u32 vcc, s97, v25
    v_cmp_ge_u32 s[34:35], v24, v21
    s_and_b64 vcc, vcc, s[34:35]
    v_cmp_gt_u32 s[34:35], 16, v24
    s_and_b64 vcc, vcc, s[34:35]
    v_cmp_eq_u32 s[34:35], 0, v21
    s_or_b64 vcc, vcc, s[34:35]
    s_add_u32 s33, s33, 1
    s_cmp_ge_u32 s33, 262144
    s_cbranch_scc1 Lfp5_d
    s_cmp_eq_u64 vcc, exec
    s_cbranch_scc1 Lfp5_d
    s_sleep 1
    s_branch Lfp5
    Lfp5_d:

Lfc4:
gated_mix__ssm_conv_h3__dense_activation_gelu__prompt_kernel_noA2:
    s_barrier
    v_and_b32 v11, 31, v1
    v_lshlrev_b32 v11, 3, v11
    v_add_u32 v11, 143360, v11
    ds_read_b64 v[112:113], v11
    v_lshlrev_b32 v12, 1, v8
    v_lshlrev_b32 v13, 15, v7
    v_add_u32 v12, v12, v13
    s_lshl_b32 s33, s17, 17
    s_add_u32 s33, s33, 2367488

    s_add_u32 s34, s33, 0
    buffer_load_ushort v136, v12, s[8:11], s34 offen sc1
    s_add_u32 s34, s33, 4096
    buffer_load_ushort v137, v12, s[8:11], s34 offen sc1
    s_add_u32 s34, s33, 8192
    buffer_load_ushort v138, v12, s[8:11], s34 offen sc1
    s_add_u32 s34, s33, 12288
    buffer_load_ushort v139, v12, s[8:11], s34 offen sc1
    s_add_u32 s34, s33, 16384
    buffer_load_ushort v140, v12, s[8:11], s34 offen sc1
    s_add_u32 s34, s33, 20480
    buffer_load_ushort v141, v12, s[8:11], s34 offen sc1
    s_add_u32 s34, s33, 24576
    buffer_load_ushort v142, v12, s[8:11], s34 offen sc1
    s_add_u32 s34, s33, 28672
    buffer_load_ushort v143, v12, s[8:11], s34 offen sc1
    s_add_u32 s34, s33, 65536
    buffer_load_ushort v144, v12, s[8:11], s34 offen sc1
    s_add_u32 s34, s33, 69632
    buffer_load_ushort v145, v12, s[8:11], s34 offen sc1
    s_add_u32 s34, s33, 73728
    buffer_load_ushort v146, v12, s[8:11], s34 offen sc1
    s_add_u32 s34, s33, 77824
    buffer_load_ushort v147, v12, s[8:11], s34 offen sc1
    s_add_u32 s34, s33, 81920
    buffer_load_ushort v148, v12, s[8:11], s34 offen sc1
    s_add_u32 s34, s33, 86016
    buffer_load_ushort v149, v12, s[8:11], s34 offen sc1
    s_add_u32 s34, s33, 90112
    buffer_load_ushort v150, v12, s[8:11], s34 offen sc1
    s_add_u32 s34, s33, 94208
    buffer_load_ushort v151, v12, s[8:11], s34 offen sc1
    s_branch gated_mix__ssm_conv_h3__dense_activation_gelu__prompt_kernel_fin_tile
gated_mix__ssm_conv_h3__dense_activation_gelu__prompt_kernel_exp_done:
    v_mov_b32 v58, 163520
    ds_read_b64 v[56:57], v58
    s_waitcnt lgkmcnt(0)
    v_readfirstlane_b32 s96, v56
    v_readfirstlane_b32 s97, v57
    s_nop 3

    s_cmp_eq_u32 s41, 1
    s_cbranch_scc1 gated_mix__ssm_conv_h3__dense_activation_gelu__prompt_kernel_nox
    s_waitcnt vmcnt(0)
    s_or_b32 s33, s96, 1
    v_mov_b32 v56, s33
    v_mov_b32 v57, s97
    s_lshl_b32 s33, s40, 6
    v_mov_b32 v58, s33
    s_mov_b64 s[30:31], exec
    s_mov_b64 exec, 1
    buffer_store_dwordx2 v[56:57], v58, s[92:95], 0 offen sc1
    s_mov_b64 exec, s[30:31]

gated_mix__ssm_conv_h3__dense_activation_gelu__prompt_kernel_nox:
    s_barrier
    s_cmp_ge_u32 s98, 2
    s_cbranch_scc1 gated_mix__ssm_conv_h3__dense_activation_gelu__prompt_kernel_nopre
    s_add_u32 s29, s98, 4
    s_mul_i32 s17, s17, 6
    s_add_u32 s17, s17, s29

    s_load_dwordx2 s[36:37], s[0:1], 0
    s_load_dwordx2 s[38:39], s[0:1], 80
    s_load_dwordx2 s[48:49], s[0:1], 96
    s_waitcnt lgkmcnt(0)
    s_mov_b32 s12, s48
    s_mov_b32 s13, s49
    s_mov_b32 s14, 2359296
    s_mov_b32 s15, 0x00020000
    s_mov_b32 s20, s36
    s_mov_b32 s21, s37
    s_mov_b32 s22, 2359296
    s_mov_b32 s23, 0x00020000
    s_mov_b32 s24, s38
    s_mov_b32 s25, s39
    s_mov_b32 s26, 1152
    s_mov_b32 s27, 0x00020000
    v_and_b32 v6, 31, v1
    v_lshrrev_b32 v7, 5, v1
    s_lshl_b32 s33, s16, 7
    s_lshl_b32 s34, s18, 5
    s_add_u32 s33, s33, s34
    v_add_u32 v8, s33, v6
    s_movk_i32 s34, 1152
    v_mul_lo_u32 v9, v8, s34
    v_lshlrev_b32 v10, 4, v7
    s_lshl_b32 s34, s17, 6
    v_add_u32 v10, s34, v10
    v_add_u32 v9, v9, v10
    buffer_load_dwordx4 v[96:99], v9, s[20:23], 0 offen
    buffer_load_dwordx4 v[100:103], v9, s[20:23], 0 offen offset:32
    buffer_load_dwordx4 v[104:107], v10, s[24:27], 0 offen
    buffer_load_dwordx4 v[108:111], v10, s[24:27], 0 offen offset:32

    v_and_b32 v11, 31, v1
    v_lshlrev_b32 v11, 3, v11
    v_add_u32 v11, 143360, v11
    ds_read_b64 v[112:113], v11
    v_lshlrev_b32 v12, 1, v8
    v_lshlrev_b32 v13, 15, v7
    v_add_u32 v12, v12, v13
    s_lshl_b32 s33, s17, 17
    s_add_u32 s33, s33, 2367488

    s_add_u32 s34, s33, 0
    buffer_load_ushort v136, v12, s[8:11], s34 offen sc1
    s_add_u32 s34, s33, 4096
    buffer_load_ushort v137, v12, s[8:11], s34 offen sc1
    s_add_u32 s34, s33, 8192
    buffer_load_ushort v138, v12, s[8:11], s34 offen sc1
    s_add_u32 s34, s33, 12288
    buffer_load_ushort v139, v12, s[8:11], s34 offen sc1
    s_add_u32 s34, s33, 16384
    buffer_load_ushort v140, v12, s[8:11], s34 offen sc1
    s_add_u32 s34, s33, 20480
    buffer_load_ushort v141, v12, s[8:11], s34 offen sc1
    s_add_u32 s34, s33, 24576
    buffer_load_ushort v142, v12, s[8:11], s34 offen sc1
    s_add_u32 s34, s33, 28672
    buffer_load_ushort v143, v12, s[8:11], s34 offen sc1
    s_add_u32 s34, s33, 65536
    buffer_load_ushort v144, v12, s[8:11], s34 offen sc1
    s_add_u32 s34, s33, 69632
    buffer_load_ushort v145, v12, s[8:11], s34 offen sc1
    s_add_u32 s34, s33, 73728
    buffer_load_ushort v146, v12, s[8:11], s34 offen sc1
    s_add_u32 s34, s33, 77824
    buffer_load_ushort v147, v12, s[8:11], s34 offen sc1
    s_add_u32 s34, s33, 81920
    buffer_load_ushort v148, v12, s[8:11], s34 offen sc1
    s_add_u32 s34, s33, 86016
    buffer_load_ushort v149, v12, s[8:11], s34 offen sc1
    s_add_u32 s34, s33, 90112
    buffer_load_ushort v150, v12, s[8:11], s34 offen sc1
    s_add_u32 s34, s33, 94208
    buffer_load_ushort v151, v12, s[8:11], s34 offen sc1
gated_mix__ssm_conv_h3__dense_activation_gelu__prompt_kernel_nopre:
    s_cmp_eq_u32 s41, 1
    s_cbranch_scc0 gated_mix__ssm_conv_h3__dense_activation_gelu__prompt_kernel_postx
gated_mix__ssm_conv_h3__dense_activation_gelu__prompt_kernel_kpoll:
    v_lshlrev_b32 v16, 2, v1
    v_add_u32 v16, s40, v16
    v_min_u32 v16, 1679, v16
    v_lshlrev_b32 v16, 6, v16
    v_mov_b32 v17, 0
    v_mov_b32 v18, 1
    v_cmp_gt_u32 vcc, 4, v1
    s_nop 1
    v_cndmask_b32 v17, v17, v18, vcc
    v_cmp_eq_u32 vcc, s18, v1
    v_mov_b32 v18, 0
    s_nop 1
    v_cndmask_b32 v17, v17, v18, vcc

    s_mov_b32 s33, 0
    Lfp6:
    buffer_load_dwordx2 v[18:19], v16, s[92:95], 0 offen sc1
    s_waitcnt vmcnt(0)
    v_subrev_u32 v18, s96, v18
    v_cmp_eq_u32 vcc, s97, v19
    v_cmp_ge_u32 s[34:35], v18, v17
    s_and_b64 vcc, vcc, s[34:35]
    v_cmp_gt_u32 s[34:35], 16, v18
    s_and_b64 vcc, vcc, s[34:35]
    v_cmp_eq_u32 s[34:35], 0, v17
    s_or_b64 vcc, vcc, s[34:35]
    s_add_u32 s33, s33, 1
    s_cmp_ge_u32 s33, 262144
    s_cbranch_scc1 Lfp6_d
    s_cmp_eq_u64 vcc, exec
    s_cbranch_scc1 Lfp6_d
    s_sleep 1
    s_branch Lfp6
    Lfp6_d:

gated_mix__ssm_conv_h3__dense_activation_gelu__prompt_kernel_postx:
    s_cmp_ge_u32 s98, 2
    s_cbranch_scc1 gated_mix__ssm_conv_h3__dense_activation_gelu__prompt_kernel_w6
gated_mix__ssm_conv_h3__dense_activation_gelu__prompt_kernel_fin_tile:
    v_lshlrev_b32 v5, 4, v1
    s_lshl_b32 s33, s16, 2
    s_add_u32 s33, s33, s18
    s_mul_i32 s33, s33, 18
    s_add_u32 s33, s33, s17
    s_lshl_b32 s33, s33, 11
    s_add_u32 s33, s33, 24117248
    s_barrier
    s_lshl_b32 s34, s29, 12
    v_add_u32 v6, s34, v5
    ds_read_b128 v[32:35], v6
    ds_read_b128 v[36:39], v6 offset:1024
    ds_read_b128 v[40:43], v6 offset:2048
    ds_read_b128 v[44:47], v6 offset:3072

    s_add_u32 s34, s18, 1
    s_and_b32 s34, s34, 3
    s_mul_i32 s34, s34, 2359296
    s_add_u32 s34, s34, s33
    buffer_load_dwordx4 v[48:51], v5, s[8:11], s34 offen sc1
    buffer_load_dwordx4 v[52:55], v5, s[8:11], s34 offen offset:1024 sc1
    s_add_u32 s34, s18, 2
    s_and_b32 s34, s34, 3
    s_mul_i32 s34, s34, 2359296
    s_add_u32 s34, s34, s33
    buffer_load_dwordx4 v[56:59], v5, s[8:11], s34 offen sc1
    buffer_load_dwordx4 v[60:63], v5, s[8:11], s34 offen offset:1024 sc1
    s_add_u32 s34, s18, 3
    s_and_b32 s34, s34, 3
    s_mul_i32 s34, s34, 2359296
    s_add_u32 s34, s34, s33
    buffer_load_dwordx4 v[64:67], v5, s[8:11], s34 offen sc1
    buffer_load_dwordx4 v[68:71], v5, s[8:11], s34 offen offset:1024 sc1
    s_waitcnt vmcnt(0) lgkmcnt(0)
    v_lshlrev_b32 v16, 16, v48
    v_and_b32 v17, 0xffff0000, v48
    v_add_f32 v32, v32, v16
    v_add_f32 v33, v33, v17
    v_lshlrev_b32 v16, 16, v49
    v_and_b32 v17, 0xffff0000, v49
    v_add_f32 v34, v34, v16
    v_add_f32 v35, v35, v17
    v_lshlrev_b32 v16, 16, v50
    v_and_b32 v17, 0xffff0000, v50
    v_add_f32 v36, v36, v16
    v_add_f32 v37, v37, v17
    v_lshlrev_b32 v16, 16, v51
    v_and_b32 v17, 0xffff0000, v51
    v_add_f32 v38, v38, v16
    v_add_f32 v39, v39, v17
    v_lshlrev_b32 v16, 16, v52
    v_and_b32 v17, 0xffff0000, v52
    v_add_f32 v40, v40, v16
    v_add_f32 v41, v41, v17
    v_lshlrev_b32 v16, 16, v53
    v_and_b32 v17, 0xffff0000, v53
    v_add_f32 v42, v42, v16
    v_add_f32 v43, v43, v17
    v_lshlrev_b32 v16, 16, v54
    v_and_b32 v17, 0xffff0000, v54
    v_add_f32 v44, v44, v16
    v_add_f32 v45, v45, v17
    v_lshlrev_b32 v16, 16, v55
    v_and_b32 v17, 0xffff0000, v55
    v_add_f32 v46, v46, v16
    v_add_f32 v47, v47, v17
    v_lshlrev_b32 v16, 16, v56
    v_and_b32 v17, 0xffff0000, v56
    v_add_f32 v32, v32, v16
    v_add_f32 v33, v33, v17
    v_lshlrev_b32 v16, 16, v57
    v_and_b32 v17, 0xffff0000, v57
    v_add_f32 v34, v34, v16
    v_add_f32 v35, v35, v17
    v_lshlrev_b32 v16, 16, v58
    v_and_b32 v17, 0xffff0000, v58
    v_add_f32 v36, v36, v16
    v_add_f32 v37, v37, v17
    v_lshlrev_b32 v16, 16, v59
    v_and_b32 v17, 0xffff0000, v59
    v_add_f32 v38, v38, v16
    v_add_f32 v39, v39, v17
    v_lshlrev_b32 v16, 16, v60
    v_and_b32 v17, 0xffff0000, v60
    v_add_f32 v40, v40, v16
    v_add_f32 v41, v41, v17
    v_lshlrev_b32 v16, 16, v61
    v_and_b32 v17, 0xffff0000, v61
    v_add_f32 v42, v42, v16
    v_add_f32 v43, v43, v17
    v_lshlrev_b32 v16, 16, v62
    v_and_b32 v17, 0xffff0000, v62
    v_add_f32 v44, v44, v16
    v_add_f32 v45, v45, v17
    v_lshlrev_b32 v16, 16, v63
    v_and_b32 v17, 0xffff0000, v63
    v_add_f32 v46, v46, v16
    v_add_f32 v47, v47, v17
    v_lshlrev_b32 v16, 16, v64
    v_and_b32 v17, 0xffff0000, v64
    v_add_f32 v32, v32, v16
    v_add_f32 v33, v33, v17
    v_lshlrev_b32 v16, 16, v65
    v_and_b32 v17, 0xffff0000, v65
    v_add_f32 v34, v34, v16
    v_add_f32 v35, v35, v17
    v_lshlrev_b32 v16, 16, v66
    v_and_b32 v17, 0xffff0000, v66
    v_add_f32 v36, v36, v16
    v_add_f32 v37, v37, v17
    v_lshlrev_b32 v16, 16, v67
    v_and_b32 v17, 0xffff0000, v67
    v_add_f32 v38, v38, v16
    v_add_f32 v39, v39, v17
    v_lshlrev_b32 v16, 16, v68
    v_and_b32 v17, 0xffff0000, v68
    v_add_f32 v40, v40, v16
    v_add_f32 v41, v41, v17
    v_lshlrev_b32 v16, 16, v69
    v_and_b32 v17, 0xffff0000, v69
    v_add_f32 v42, v42, v16
    v_add_f32 v43, v43, v17
    v_lshlrev_b32 v16, 16, v70
    v_and_b32 v17, 0xffff0000, v70
    v_add_f32 v44, v44, v16
    v_add_f32 v45, v45, v17
    v_lshlrev_b32 v16, 16, v71
    v_and_b32 v17, 0xffff0000, v71
    v_add_f32 v46, v46, v16
    v_add_f32 v47, v47, v17
    v_lshlrev_b32 v16, 16, v104
    v_and_b32 v17, 0xffff0000, v104
    v_add_f32 v32, v32, v16
    v_add_f32 v33, v33, v17
    v_lshlrev_b32 v16, 16, v96
    v_and_b32 v17, 0xffff0000, v96
    v_lshlrev_b32 v18, 16, v136
    v_lshlrev_b32 v19, 16, v137
    v_mul_f32 v32, v32, v113
    v_mul_f32 v33, v33, v113
    v_mul_f32 v16, v16, v18
    v_mul_f32 v17, v17, v19
    v_fmac_f32 v32, v16, v112
    v_fmac_f32 v33, v17, v112
    v_cvt_pk_bf16_f32 v124, v32, v33
    v_lshlrev_b32 v16, 16, v105
    v_and_b32 v17, 0xffff0000, v105
    v_add_f32 v34, v34, v16
    v_add_f32 v35, v35, v17
    v_lshlrev_b32 v16, 16, v97
    v_and_b32 v17, 0xffff0000, v97
    v_lshlrev_b32 v18, 16, v138
    v_lshlrev_b32 v19, 16, v139
    v_mul_f32 v34, v34, v113
    v_mul_f32 v35, v35, v113
    v_mul_f32 v16, v16, v18
    v_mul_f32 v17, v17, v19
    v_fmac_f32 v34, v16, v112
    v_fmac_f32 v35, v17, v112
    v_cvt_pk_bf16_f32 v125, v34, v35
    v_lshlrev_b32 v16, 16, v106
    v_and_b32 v17, 0xffff0000, v106
    v_add_f32 v36, v36, v16
    v_add_f32 v37, v37, v17
    v_lshlrev_b32 v16, 16, v98
    v_and_b32 v17, 0xffff0000, v98
    v_lshlrev_b32 v18, 16, v140
    v_lshlrev_b32 v19, 16, v141
    v_mul_f32 v36, v36, v113
    v_mul_f32 v37, v37, v113
    v_mul_f32 v16, v16, v18
    v_mul_f32 v17, v17, v19
    v_fmac_f32 v36, v16, v112
    v_fmac_f32 v37, v17, v112
    v_cvt_pk_bf16_f32 v126, v36, v37
    v_lshlrev_b32 v16, 16, v107
    v_and_b32 v17, 0xffff0000, v107
    v_add_f32 v38, v38, v16
    v_add_f32 v39, v39, v17
    v_lshlrev_b32 v16, 16, v99
    v_and_b32 v17, 0xffff0000, v99
    v_lshlrev_b32 v18, 16, v142
    v_lshlrev_b32 v19, 16, v143
    v_mul_f32 v38, v38, v113
    v_mul_f32 v39, v39, v113
    v_mul_f32 v16, v16, v18
    v_mul_f32 v17, v17, v19
    v_fmac_f32 v38, v16, v112
    v_fmac_f32 v39, v17, v112
    v_cvt_pk_bf16_f32 v127, v38, v39
    v_lshlrev_b32 v16, 16, v108
    v_and_b32 v17, 0xffff0000, v108
    v_add_f32 v40, v40, v16
    v_add_f32 v41, v41, v17
    v_lshlrev_b32 v16, 16, v100
    v_and_b32 v17, 0xffff0000, v100
    v_lshlrev_b32 v18, 16, v144
    v_lshlrev_b32 v19, 16, v145
    v_mul_f32 v40, v40, v113
    v_mul_f32 v41, v41, v113
    v_mul_f32 v16, v16, v18
    v_mul_f32 v17, v17, v19
    v_fmac_f32 v40, v16, v112
    v_fmac_f32 v41, v17, v112
    v_cvt_pk_bf16_f32 v128, v40, v41
    v_lshlrev_b32 v16, 16, v109
    v_and_b32 v17, 0xffff0000, v109
    v_add_f32 v42, v42, v16
    v_add_f32 v43, v43, v17
    v_lshlrev_b32 v16, 16, v101
    v_and_b32 v17, 0xffff0000, v101
    v_lshlrev_b32 v18, 16, v146
    v_lshlrev_b32 v19, 16, v147
    v_mul_f32 v42, v42, v113
    v_mul_f32 v43, v43, v113
    v_mul_f32 v16, v16, v18
    v_mul_f32 v17, v17, v19
    v_fmac_f32 v42, v16, v112
    v_fmac_f32 v43, v17, v112
    v_cvt_pk_bf16_f32 v129, v42, v43
    v_lshlrev_b32 v16, 16, v110
    v_and_b32 v17, 0xffff0000, v110
    v_add_f32 v44, v44, v16
    v_add_f32 v45, v45, v17
    v_lshlrev_b32 v16, 16, v102
    v_and_b32 v17, 0xffff0000, v102
    v_lshlrev_b32 v18, 16, v148
    v_lshlrev_b32 v19, 16, v149
    v_mul_f32 v44, v44, v113
    v_mul_f32 v45, v45, v113
    v_mul_f32 v16, v16, v18
    v_mul_f32 v17, v17, v19
    v_fmac_f32 v44, v16, v112
    v_fmac_f32 v45, v17, v112
    v_cvt_pk_bf16_f32 v130, v44, v45
    v_lshlrev_b32 v16, 16, v111
    v_and_b32 v17, 0xffff0000, v111
    v_add_f32 v46, v46, v16
    v_add_f32 v47, v47, v17
    v_lshlrev_b32 v16, 16, v103
    v_and_b32 v17, 0xffff0000, v103
    v_lshlrev_b32 v18, 16, v150
    v_lshlrev_b32 v19, 16, v151
    v_mul_f32 v46, v46, v113
    v_mul_f32 v47, v47, v113
    v_mul_f32 v16, v16, v18
    v_mul_f32 v17, v17, v19
    v_fmac_f32 v46, v16, v112
    v_fmac_f32 v47, v17, v112
    v_cvt_pk_bf16_f32 v131, v46, v47
    buffer_store_dwordx4 v[124:127], v9, s[12:15], 0 offen
    buffer_store_dwordx4 v[128:131], v9, s[12:15], 0 offen offset:32
    s_waitcnt vmcnt(0)
    s_branch gated_mix__ssm_conv_h3__dense_activation_gelu__prompt_kernel_fin_done

gated_mix__ssm_conv_h3__dense_activation_gelu__prompt_kernel_w6:
    s_barrier
    s_branch gated_mix__ssm_conv_h3__dense_activation_gelu__prompt_kernel_fin_done
gated_mix__ssm_conv_h3__dense_activation_gelu__prompt_kernel_fin_done:
    s_branch gated_mix__ssm_conv_h3__dense_activation_gelu__prompt_kernel_fin
gated_mix__ssm_conv_h3__dense_activation_gelu__prompt_kernel_conv:
    s_lshl_b32 s99, s16, 2
    s_add_u32 s99, s99, s18
    s_mov_b32 s8, s42
    s_mov_b32 s9, s43
    s_mov_b32 s10, 4747264
    s_mov_b32 s11, 0x00020000
    s_mul_i32 s23, s99, 9
    s_add_u32 s16, s23, 8

    s_lshl_b32 s33, s16, 12
    s_add_u32 s12, s36, s33
    s_addc_u32 s13, s37, 0
    s_sub_u32 s14, 2359296, s33
    s_mov_b32 s15, 0x00020000
    s_lshl_b32 s24, s16, 1
    s_and_b32 s33, s24, 0xfffffffc
    s_add_u32 s34, s38, s33
    s_addc_u32 s35, s39, 0
    s_load_dword s25, s[34:35], 0
    s_add_u32 s16, s23, s98
    s_mov_b32 s17, s98

    s_lshr_b32 s33, s17, 2
    s_mul_i32 s33, s33, 81920
    s_and_b32 s34, s17, 3
    s_mul_i32 s26, s34, 8128
    s_add_u32 s26, s26, s33
    s_add_u32 s27, s26, 49088
    s_add_u32 s26, s26, 16448
    s_mul_i32 s28, s34, 4112
    s_add_u32 s28, s28, s33
    s_mov_b32 s29, s27

    s_lshl_b32 s33, s16, 12
    s_add_u32 s4, s36, s33
    s_addc_u32 s5, s37, 0
    s_sub_u32 s6, 2359296, s33
    s_mov_b32 s7, 0x00020000
    s_lshl_b32 s20, s16, 1
    s_and_b32 s33, s20, 0xfffffffc
    s_add_u32 s34, s38, s33
    s_addc_u32 s35, s39, 0
    s_load_dword s21, s[34:35], 0
    s_lshl_b32 s22, s16, 12
    s_add_u32 s22, s22, 4096

    v_lshlrev_b32 v10, 4, v1
    v_and_b32 v11, 1, v1
    v_lshrrev_b32 v12, 1, v1
    v_lshlrev_b32 v11, 2, v11
    v_lshl_add_u32 v11, v12, 4, v11
    v_add_u32 v11, 32, v11

    v_mov_b32 v30, 163520
    ds_read_b64 v[28:29], v30
    s_waitcnt lgkmcnt(0)
    v_readfirstlane_b32 s96, v28
    v_readfirstlane_b32 s97, v29
    s_nop 3

    s_lshr_b32 s33, s23, 6
    s_add_u32 s34, s23, 8
    s_lshr_b32 s34, s34, 6
    v_and_b32 v28, 15, v1
    v_mul_u32_u24 v28, 9, v28
    v_mov_b32 v29, s33
    v_mov_b32 v30, s34
    v_cmp_gt_u32 vcc, 16, v1
    s_nop 1
    v_cndmask_b32 v29, v30, v29, vcc
    v_add_u32 v28, v28, v29
    v_add_u32 v28, 0, v28
    v_lshlrev_b32 v28, 6, v28
    v_mov_b32 v29, 1
    v_mov_b32 v30, 0
    v_cmp_gt_u32 vcc, 32, v1
    s_nop 1
    v_cndmask_b32 v29, v30, v29, vcc
    buffer_load_dwordx2 v[32:33], v28, s[92:95], 0 offen sc1

    buffer_load_dwordx4 v[20:23], v10, s[4:7], 0 offen
    s_add_u32 m0, s26, 0
    s_movk_i32 s33, 0
    buffer_load_dwordx4 v11, s[4:7], s33 offen lds
    buffer_load_dwordx4 v[48:51], v11, s[4:7], s33 offen
    buffer_load_dwordx4 v[52:55], v11, s[4:7], s33 offen offset:4
    s_add_u32 m0, s26, 1024
    s_movk_i32 s33, 512
    buffer_load_dwordx4 v11, s[4:7], s33 offen lds
    buffer_load_dwordx4 v[56:59], v11, s[4:7], s33 offen
    buffer_load_dwordx4 v[60:63], v11, s[4:7], s33 offen offset:4
    s_add_u32 m0, s26, 2048
    s_movk_i32 s33, 1024
    buffer_load_dwordx4 v11, s[4:7], s33 offen lds
    buffer_load_dwordx4 v[64:67], v11, s[4:7], s33 offen
    buffer_load_dwordx4 v[68:71], v11, s[4:7], s33 offen offset:4
    s_add_u32 m0, s26, 3072
    s_movk_i32 s33, 1536
    buffer_load_dwordx4 v11, s[4:7], s33 offen lds
    buffer_load_dwordx4 v[72:75], v11, s[4:7], s33 offen
    buffer_load_dwordx4 v[76:79], v11, s[4:7], s33 offen offset:4
    s_waitcnt vmcnt(13)
    s_cmp_eq_u32 s19, 0
    s_cbranch_scc1 gated_mix__ssm_conv_h3__dense_activation_gelu__prompt_kernel_nohc
    v_mov_b32 v34, 81600
    v_mov_b32 v35, 1
    s_mov_b64 exec, 1
    ds_add_u32 v34, v35
    s_mov_b64 exec, -1
            gated_mix__ssm_conv_h3__dense_activation_gelu__prompt_kernel_nohc:

    v_subrev_u32 v32, s96, v32
    v_cmp_eq_u32 vcc, s97, v33
    v_cmp_ge_u32 s[34:35], v32, v29
    s_and_b64 vcc, vcc, s[34:35]
    v_cmp_gt_u32 s[34:35], 16, v32
    s_and_b64 vcc, vcc, s[34:35]
    v_cmp_eq_u32 s[34:35], 0, v29
    s_or_b64 vcc, vcc, s[34:35]
    s_cmp_eq_u64 vcc, exec
    s_cbranch_scc1 Lfc7

    s_mov_b32 s33, 0
    Lfp8:
    buffer_load_dwordx2 v[30:31], v28, s[92:95], 0 offen sc1
    s_waitcnt vmcnt(0)
    v_subrev_u32 v30, s96, v30
    v_cmp_eq_u32 vcc, s97, v31
    v_cmp_ge_u32 s[34:35], v30, v29
    s_and_b64 vcc, vcc, s[34:35]
    v_cmp_gt_u32 s[34:35], 16, v30
    s_and_b64 vcc, vcc, s[34:35]
    v_cmp_eq_u32 s[34:35], 0, v29
    s_or_b64 vcc, vcc, s[34:35]
    s_add_u32 s33, s33, 1
    s_cmp_ge_u32 s33, 262144
    s_cbranch_scc1 Lfp8_d
    s_cmp_eq_u64 vcc, exec
    s_cbranch_scc1 Lfp8_d
    s_sleep 1
    s_branch Lfp8
    Lfp8_d:

Lfc7:
    s_add_u32 m0, s28, 0
    s_add_u32 s33, s22, 0
    buffer_load_dwordx4 v10, s[8:11], s33 offen sc1 lds
    s_add_u32 m0, s28, 1024
    s_add_u32 s33, s22, 1024
    buffer_load_dwordx4 v10, s[8:11], s33 offen sc1 lds
    s_add_u32 m0, s28, 2048
    s_add_u32 s33, s22, 2048
    buffer_load_dwordx4 v10, s[8:11], s33 offen sc1 lds
    s_add_u32 m0, s28, 3072
    s_add_u32 s33, s22, 3072
    buffer_load_dwordx4 v10, s[8:11], s33 offen sc1 lds
    s_add_u32 m0, s26, 4096
    s_movk_i32 s33, 2048
    buffer_load_dwordx4 v11, s[4:7], s33 offen lds
    buffer_load_dwordx4 v[80:83], v11, s[4:7], s33 offen
    buffer_load_dwordx4 v[84:87], v11, s[4:7], s33 offen offset:4
    s_add_u32 m0, s26, 5120
    s_movk_i32 s33, 2560
    buffer_load_dwordx4 v11, s[4:7], s33 offen lds
    buffer_load_dwordx4 v[88:91], v11, s[4:7], s33 offen
    buffer_load_dwordx4 v[92:95], v11, s[4:7], s33 offen offset:4
    s_add_u32 m0, s26, 6144
    s_movk_i32 s33, 3072
    buffer_load_dwordx4 v11, s[4:7], s33 offen lds
    buffer_load_dwordx4 v[96:99], v11, s[4:7], s33 offen
    buffer_load_dwordx4 v[100:103], v11, s[4:7], s33 offen offset:4
    s_mov_b32 exec_hi, 0x0fffffff
    s_add_u32 m0, s26, 7168
    s_movk_i32 s33, 3584
    buffer_load_dwordx4 v11, s[4:7], s33 offen lds
    s_mov_b32 exec_hi, -1
    buffer_load_dwordx4 v[104:107], v11, s[4:7], s33 offen
    buffer_load_dwordx4 v[108:111], v11, s[4:7], s33 offen offset:4
    s_cmp_ge_u32 s98, 4
    s_cbranch_scc1 gated_mix__ssm_conv_h3__dense_activation_gelu__prompt_kernel_no9pf
    s_lshl_b32 s33, s98, 9
    buffer_load_dwordx4 v[176:179], v11, s[12:15], s33 offen
    buffer_load_dwordx4 v[180:183], v11, s[12:15], s33 offen offset:4
    s_add_u32 s33, s33, 2048
    buffer_load_dwordx4 v[184:187], v11, s[12:15], s33 offen
    buffer_load_dwordx4 v[188:191], v11, s[12:15], s33 offen offset:4
    buffer_load_dwordx4 v[196:199], v10, s[12:15], 0 offen
    s_add_u32 s33, s23, 8
    s_lshl_b32 s33, s33, 12
    s_lshl_b32 s34, s98, 10
    s_add_u32 s33, s33, s34
    s_add_u32 s33, s33, 4096
    buffer_load_dwordx4 v[192:195], v10, s[8:11], s33 offen sc1
    s_branch gated_mix__ssm_conv_h3__dense_activation_gelu__prompt_kernel_9pfd
    gated_mix__ssm_conv_h3__dense_activation_gelu__prompt_kernel_no9pf:

    buffer_load_dword v176, v10, s[4:7], 0 offen
    buffer_load_dword v177, v10, s[4:7], 0 offen
    buffer_load_dword v178, v10, s[4:7], 0 offen
    buffer_load_dword v179, v10, s[4:7], 0 offen
    gated_mix__ssm_conv_h3__dense_activation_gelu__prompt_kernel_9pfd:
    v_add_u32 v13, s27, v10

    s_waitcnt vmcnt(20)
    v_mov_b32 v24, 0
    v_mov_b32 v25, 0
    v_mov_b32 v26, 0
    v_mov_b32 v27, 0
    v_add_u32 v8, s29, v10
    s_add_u32 s33, s28, 4096
    v_mov_b32 v9, s33
    s_mov_b64 exec, 3
    ds_write_b128 v8, v[24:27]
    s_mov_b64 exec, 1
    ds_write_b128 v9, v[24:27]
    s_mov_b64 exec, 15
    ds_write_b128 v8, v[20:23] offset:32
    s_mov_b64 exec, -1

    v_and_b32 v14, 15, v1
    v_lshrrev_b32 v15, 4, v1
    v_lshl_add_u32 v14, v15, 3, v14
    v_add_u32 v14, 1, v14
    v_lshlrev_b32 v14, 1, v14
    v_add_u32 v14, s29, v14
    s_waitcnt lgkmcnt(0)
    ds_read_b128 v[16:19], v14
    s_waitcnt lgkmcnt(0)

    v_alignbit_b32 v48, v52, v48, 16
    v_alignbit_b32 v49, v53, v49, 16
    v_alignbit_b32 v50, v54, v50, 16
    v_alignbit_b32 v51, v55, v51, 16
    ds_write_b128 v13, v[48:51] offset:0
    v_alignbit_b32 v56, v60, v56, 16
    v_alignbit_b32 v57, v61, v57, 16
    v_alignbit_b32 v58, v62, v58, 16
    v_alignbit_b32 v59, v63, v59, 16
    ds_write_b128 v13, v[56:59] offset:1024
    v_alignbit_b32 v64, v68, v64, 16
    v_alignbit_b32 v65, v69, v65, 16
    v_alignbit_b32 v66, v70, v66, 16
    v_alignbit_b32 v67, v71, v67, 16
    ds_write_b128 v13, v[64:67] offset:2048
    v_alignbit_b32 v72, v76, v72, 16
    v_alignbit_b32 v73, v77, v73, 16
    v_alignbit_b32 v74, v78, v74, 16
    v_alignbit_b32 v75, v79, v75, 16
    ds_write_b128 v13, v[72:75] offset:3072
    s_waitcnt vmcnt(13)
    v_alignbit_b32 v80, v84, v80, 16
    v_alignbit_b32 v81, v85, v81, 16
    v_alignbit_b32 v82, v86, v82, 16
    v_alignbit_b32 v83, v87, v83, 16
    ds_write_b128 v13, v[80:83] offset:4096
    s_waitcnt vmcnt(10)
    v_alignbit_b32 v88, v92, v88, 16
    v_alignbit_b32 v89, v93, v89, 16
    v_alignbit_b32 v90, v94, v90, 16
    v_alignbit_b32 v91, v95, v91, 16
    ds_write_b128 v13, v[88:91] offset:5120
    s_waitcnt vmcnt(7)
    v_alignbit_b32 v96, v100, v96, 16
    v_alignbit_b32 v97, v101, v97, 16
    v_alignbit_b32 v98, v102, v98, 16
    v_alignbit_b32 v99, v103, v99, 16
    ds_write_b128 v13, v[96:99] offset:6144
    s_waitcnt vmcnt(4)
    v_alignbit_b32 v104, v108, v104, 16
    v_alignbit_b32 v105, v109, v105, 16
    v_alignbit_b32 v106, v110, v106, 16
    v_alignbit_b32 v107, v111, v107, 16
    s_mov_b32 exec_hi, 0x0fffffff
    ds_write_b128 v13, v[104:107] offset:7168
    s_mov_b32 exec_hi, -1
    v_and_b32 v10, 15, v1
    v_lshrrev_b32 v11, 4, v1
    v_add_u32 v12, 1, v10
    v_and_b32 v13, 3, v12
    v_lshrrev_b32 v12, 2, v12
    v_lshl_add_u32 v12, v11, 1, v12
    v_and_b32 v15, 1, v13
    v_mov_b32 v9, s26
    v_mov_b32 v8, s27
    v_cmp_eq_u32 vcc, 1, v15
    s_nop 1
    v_cndmask_b32 v9, v9, v8, vcc
    v_lshrrev_b32 v13, 1, v13
    v_lshl_add_u32 v9, v13, 4, v9
    v_subrev_u32 v9, 128, v9

    v_lshrrev_b32 v14, 1, v12
    v_lshl_add_u32 v14, v14, 5, v9
    v_and_b32 v15, 1, v12
    v_lshl_add_u32 v4, v15, 3, v14
    v_add_u32 v12, 1, v12
    v_lshrrev_b32 v14, 1, v12
    v_lshl_add_u32 v14, v14, 5, v9
    v_and_b32 v15, 1, v12
    v_lshl_add_u32 v5, v15, 3, v14
    v_lshlrev_b32 v14, 5, v10
    v_lshlrev_b32 v15, 4, v11
    v_sub_u32 v14, v15, v14
    s_add_u32 s33, s28, 480

    v_add_u32 v6, s33, v14
    v_add_u32 v8, 3584, v6
    s_add_u32 s33, s28, 4096
    v_mov_b32 v9, s33
    v_min_u32 v7, v8, v9
    v_lshl_add_u32 v14, v11, 3, v10
    v_add_u32 v14, 1, v14
    v_lshlrev_b32 v14, 1, v14
    v_add_u32 v14, s29, v14

    v_mov_b32 v144, 0
    v_mov_b32 v145, 0
    v_mov_b32 v146, 0
    v_mov_b32 v147, 0
    v_mov_b32 v148, 0
    v_mov_b32 v149, 0
    v_mov_b32 v150, 0
    v_mov_b32 v151, 0
    v_mov_b32 v152, 0
    v_mov_b32 v153, 0
    v_mov_b32 v154, 0
    v_mov_b32 v155, 0
    v_mov_b32 v156, 0
    v_mov_b32 v157, 0
    v_mov_b32 v158, 0
    v_mov_b32 v159, 0
    v_mov_b32 v160, 0
    v_mov_b32 v161, 0
    v_mov_b32 v162, 0
    v_mov_b32 v163, 0
    v_mov_b32 v164, 0
    v_mov_b32 v165, 0
    v_mov_b32 v166, 0
    v_mov_b32 v167, 0
    v_mov_b32 v168, 0
    v_mov_b32 v169, 0
    v_mov_b32 v170, 0
    v_mov_b32 v171, 0
    v_mov_b32 v172, 0
    v_mov_b32 v173, 0
    v_mov_b32 v174, 0
    v_mov_b32 v175, 0
    s_waitcnt vmcnt(0) lgkmcnt(0)
    ds_read_b64 v[20:21], v4 offset:1024
    ds_read_b64 v[22:23], v5 offset:1024
    ds_read_b64 v[24:25], v4 offset:2048
    ds_read_b64 v[26:27], v5 offset:2048
    ds_read_b64 v[28:29], v4 offset:3072
    ds_read_b64 v[30:31], v5 offset:3072
    ds_read_b64 v[32:33], v4 offset:4096
    ds_read_b64 v[34:35], v5 offset:4096
    ds_read_b64 v[36:37], v4 offset:5120
    ds_read_b64 v[38:39], v5 offset:5120
    ds_read_b64 v[40:41], v4 offset:6144
    ds_read_b64 v[42:43], v5 offset:6144
    ds_read_b64 v[44:45], v4 offset:7168
    ds_read_b64 v[46:47], v5 offset:7168
    ds_read_b128 v[80:83], v7
    ds_read_b128 v[84:87], v6 offset:3072
    ds_read_b128 v[88:91], v6 offset:2560
    ds_read_b128 v[92:95], v6 offset:2048
    ds_read_b128 v[96:99], v6 offset:1536
    ds_read_b128 v[100:103], v6 offset:1024
    ds_read_b128 v[104:107], v6 offset:512
    ds_read_b128 v[108:111], v6 offset:0
    s_waitcnt lgkmcnt(0)
    s_mov_b32 s18, 0
.p2align 6
gated_mix__ssm_conv_h3__dense_activation_gelu__prompt_kernel_cvloop:
    s_waitcnt lgkmcnt(7)
    v_mfma_f32_16x16x32_bf16 v[144:147], v[16:19], v[80:83], v[144:147]
    s_waitcnt lgkmcnt(6)
    v_mfma_f32_16x16x32_bf16 v[148:151], v[16:19], v[84:87], v[148:151]
    v_add_u32 v4, 128, v4
    v_mfma_f32_16x16x32_bf16 v[148:151], v[20:23], v[80:83], v[148:151]
    v_add_u32 v5, 128, v5
    v_mfma_f32_16x16x32_bf16 v[152:155], v[20:23], v[84:87], v[152:155]
    v_add_u32 v6, 64, v6
    s_waitcnt lgkmcnt(5)
    v_mfma_f32_16x16x32_bf16 v[152:155], v[16:19], v[88:91], v[152:155]
    v_add_u32 v8, 64, v8
    v_mfma_f32_16x16x32_bf16 v[156:159], v[20:23], v[88:91], v[156:159]
    v_min_u32 v7, v8, v9
    v_mfma_f32_16x16x32_bf16 v[152:155], v[24:27], v[80:83], v[152:155]
    ds_read_b64 v[48:49], v4 offset:0
    v_mfma_f32_16x16x32_bf16 v[156:159], v[24:27], v[84:87], v[156:159]
    ds_read_b64 v[50:51], v5 offset:0
    v_mfma_f32_16x16x32_bf16 v[160:163], v[24:27], v[88:91], v[160:163]
    ds_read_b64 v[52:53], v4 offset:1024
    s_waitcnt lgkmcnt(7)
    v_mfma_f32_16x16x32_bf16 v[156:159], v[16:19], v[92:95], v[156:159]
    ds_read_b64 v[54:55], v5 offset:1024
    v_mfma_f32_16x16x32_bf16 v[160:163], v[20:23], v[92:95], v[160:163]
    ds_read_b64 v[56:57], v4 offset:2048
    v_mfma_f32_16x16x32_bf16 v[164:167], v[24:27], v[92:95], v[164:167]
    ds_read_b64 v[58:59], v5 offset:2048
    v_mfma_f32_16x16x32_bf16 v[156:159], v[28:31], v[80:83], v[156:159]
    ds_read_b64 v[60:61], v4 offset:3072
    v_mfma_f32_16x16x32_bf16 v[160:163], v[28:31], v[84:87], v[160:163]
    ds_read_b64 v[62:63], v5 offset:3072
    v_mfma_f32_16x16x32_bf16 v[164:167], v[28:31], v[88:91], v[164:167]
    ds_read_b64 v[64:65], v4 offset:4096
    v_mfma_f32_16x16x32_bf16 v[168:171], v[28:31], v[92:95], v[168:171]
    ds_read_b64 v[66:67], v5 offset:4096
    s_waitcnt lgkmcnt(13)
    v_mfma_f32_16x16x32_bf16 v[160:163], v[16:19], v[96:99], v[160:163]
    ds_read_b64 v[68:69], v4 offset:5120
    v_mfma_f32_16x16x32_bf16 v[164:167], v[20:23], v[96:99], v[164:167]
    ds_read_b64 v[70:71], v5 offset:5120
    v_mfma_f32_16x16x32_bf16 v[168:171], v[24:27], v[96:99], v[168:171]
    ds_read_b64 v[72:73], v4 offset:6144
    v_mfma_f32_16x16x32_bf16 v[172:175], v[28:31], v[96:99], v[172:175]
    ds_read_b64 v[74:75], v5 offset:6144
    v_mfma_f32_16x16x32_bf16 v[160:163], v[32:35], v[80:83], v[160:163]
    ds_read_b64 v[76:77], v4 offset:7168
    v_mfma_f32_16x16x32_bf16 v[164:167], v[32:35], v[84:87], v[164:167]
    ds_read_b64 v[78:79], v5 offset:7168
    v_mfma_f32_16x16x32_bf16 v[168:171], v[32:35], v[88:91], v[168:171]
    ds_read_b128 v[112:115], v7
    v_mfma_f32_16x16x32_bf16 v[172:175], v[32:35], v[92:95], v[172:175]
    ds_read_b128 v[116:119], v6 offset:3072
    s_waitcnt lgkmcnt(15)
    v_mfma_f32_16x16x32_bf16 v[164:167], v[16:19], v[100:103], v[164:167]
    ds_read_b128 v[120:123], v6 offset:2560
    v_mfma_f32_16x16x32_bf16 v[168:171], v[20:23], v[100:103], v[168:171]
    ds_read_b128 v[124:127], v6 offset:2048
    v_mfma_f32_16x16x32_bf16 v[172:175], v[24:27], v[100:103], v[172:175]
    ds_read_b128 v[128:131], v6 offset:1536
    v_mfma_f32_16x16x32_bf16 v[164:167], v[36:39], v[80:83], v[164:167]
    ds_read_b128 v[132:135], v6 offset:1024
    v_mfma_f32_16x16x32_bf16 v[168:171], v[36:39], v[84:87], v[168:171]
    ds_read_b128 v[136:139], v6 offset:512
    v_mfma_f32_16x16x32_bf16 v[172:175], v[36:39], v[88:91], v[172:175]
    ds_read_b128 v[140:143], v6 offset:0
    v_mfma_f32_16x16x32_bf16 v[168:171], v[16:19], v[104:107], v[168:171]
    v_mfma_f32_16x16x32_bf16 v[172:175], v[20:23], v[104:107], v[172:175]
    v_mfma_f32_16x16x32_bf16 v[168:171], v[40:43], v[80:83], v[168:171]
    v_mfma_f32_16x16x32_bf16 v[172:175], v[40:43], v[84:87], v[172:175]
    v_mfma_f32_16x16x32_bf16 v[172:175], v[16:19], v[108:111], v[172:175]
    v_mfma_f32_16x16x32_bf16 v[172:175], v[44:47], v[80:83], v[172:175]
    s_waitcnt lgkmcnt(7)
    v_mfma_f32_16x16x32_bf16 v[144:147], v[48:51], v[112:115], v[144:147]
    s_waitcnt lgkmcnt(6)
    v_mfma_f32_16x16x32_bf16 v[148:151], v[48:51], v[116:119], v[148:151]
    v_add_u32 v4, 128, v4
    v_mfma_f32_16x16x32_bf16 v[148:151], v[52:55], v[112:115], v[148:151]
    v_add_u32 v5, 128, v5
    v_mfma_f32_16x16x32_bf16 v[152:155], v[52:55], v[116:119], v[152:155]
    v_add_u32 v6, 64, v6
    s_waitcnt lgkmcnt(5)
    v_mfma_f32_16x16x32_bf16 v[152:155], v[48:51], v[120:123], v[152:155]
    v_add_u32 v8, 64, v8
    v_mfma_f32_16x16x32_bf16 v[156:159], v[52:55], v[120:123], v[156:159]
    v_min_u32 v7, v8, v9
    v_mfma_f32_16x16x32_bf16 v[152:155], v[56:59], v[112:115], v[152:155]
    ds_read_b64 v[16:17], v4 offset:0
    v_mfma_f32_16x16x32_bf16 v[156:159], v[56:59], v[116:119], v[156:159]
    ds_read_b64 v[18:19], v5 offset:0
    v_mfma_f32_16x16x32_bf16 v[160:163], v[56:59], v[120:123], v[160:163]
    ds_read_b64 v[20:21], v4 offset:1024
    s_waitcnt lgkmcnt(7)
    v_mfma_f32_16x16x32_bf16 v[156:159], v[48:51], v[124:127], v[156:159]
    ds_read_b64 v[22:23], v5 offset:1024
    v_mfma_f32_16x16x32_bf16 v[160:163], v[52:55], v[124:127], v[160:163]
    ds_read_b64 v[24:25], v4 offset:2048
    v_mfma_f32_16x16x32_bf16 v[164:167], v[56:59], v[124:127], v[164:167]
    ds_read_b64 v[26:27], v5 offset:2048
    v_mfma_f32_16x16x32_bf16 v[156:159], v[60:63], v[112:115], v[156:159]
    ds_read_b64 v[28:29], v4 offset:3072
    v_mfma_f32_16x16x32_bf16 v[160:163], v[60:63], v[116:119], v[160:163]
    ds_read_b64 v[30:31], v5 offset:3072
    v_mfma_f32_16x16x32_bf16 v[164:167], v[60:63], v[120:123], v[164:167]
    ds_read_b64 v[32:33], v4 offset:4096
    v_mfma_f32_16x16x32_bf16 v[168:171], v[60:63], v[124:127], v[168:171]
    ds_read_b64 v[34:35], v5 offset:4096
    s_waitcnt lgkmcnt(13)
    v_mfma_f32_16x16x32_bf16 v[160:163], v[48:51], v[128:131], v[160:163]
    ds_read_b64 v[36:37], v4 offset:5120
    v_mfma_f32_16x16x32_bf16 v[164:167], v[52:55], v[128:131], v[164:167]
    ds_read_b64 v[38:39], v5 offset:5120
    v_mfma_f32_16x16x32_bf16 v[168:171], v[56:59], v[128:131], v[168:171]
    ds_read_b64 v[40:41], v4 offset:6144
    v_mfma_f32_16x16x32_bf16 v[172:175], v[60:63], v[128:131], v[172:175]
    ds_read_b64 v[42:43], v5 offset:6144
    v_mfma_f32_16x16x32_bf16 v[160:163], v[64:67], v[112:115], v[160:163]
    ds_read_b64 v[44:45], v4 offset:7168
    v_mfma_f32_16x16x32_bf16 v[164:167], v[64:67], v[116:119], v[164:167]
    ds_read_b64 v[46:47], v5 offset:7168
    v_mfma_f32_16x16x32_bf16 v[168:171], v[64:67], v[120:123], v[168:171]
    ds_read_b128 v[80:83], v7
    v_mfma_f32_16x16x32_bf16 v[172:175], v[64:67], v[124:127], v[172:175]
    ds_read_b128 v[84:87], v6 offset:3072
    s_waitcnt lgkmcnt(15)
    v_mfma_f32_16x16x32_bf16 v[164:167], v[48:51], v[132:135], v[164:167]
    ds_read_b128 v[88:91], v6 offset:2560
    v_mfma_f32_16x16x32_bf16 v[168:171], v[52:55], v[132:135], v[168:171]
    ds_read_b128 v[92:95], v6 offset:2048
    v_mfma_f32_16x16x32_bf16 v[172:175], v[56:59], v[132:135], v[172:175]
    ds_read_b128 v[96:99], v6 offset:1536
    v_mfma_f32_16x16x32_bf16 v[164:167], v[68:71], v[112:115], v[164:167]
    ds_read_b128 v[100:103], v6 offset:1024
    v_mfma_f32_16x16x32_bf16 v[168:171], v[68:71], v[116:119], v[168:171]
    ds_read_b128 v[104:107], v6 offset:512
    v_mfma_f32_16x16x32_bf16 v[172:175], v[68:71], v[120:123], v[172:175]
    ds_read_b128 v[108:111], v6 offset:0
    v_mfma_f32_16x16x32_bf16 v[168:171], v[48:51], v[136:139], v[168:171]
    v_mfma_f32_16x16x32_bf16 v[172:175], v[52:55], v[136:139], v[172:175]
    v_mfma_f32_16x16x32_bf16 v[168:171], v[72:75], v[112:115], v[168:171]
    v_mfma_f32_16x16x32_bf16 v[172:175], v[72:75], v[116:119], v[172:175]
    v_mfma_f32_16x16x32_bf16 v[172:175], v[48:51], v[140:143], v[172:175]
    v_mfma_f32_16x16x32_bf16 v[172:175], v[76:79], v[112:115], v[172:175]
    s_add_u32 s18, s18, 2
    s_cmp_lt_u32 s18, 8
    s_cbranch_scc1 gated_mix__ssm_conv_h3__dense_activation_gelu__prompt_kernel_cvloop
    s_waitcnt lgkmcnt(0)
    s_and_b32 s33, s20, 2
    s_lshl_b32 s33, s33, 3
    s_lshr_b32 s21, s21, s33
    s_lshl_b32 s21, s21, 16

    v_and_b32 v10, 15, v1
    v_lshrrev_b32 v11, 4, v1
    v_lshlrev_b32 v12, 5, v10
    v_lshl_add_u32 v12, v11, 3, v12
    s_add_u32 s33, s28, 504
    v_sub_u32 v13, s33, v12
    v_mov_b32 v14, s21
    s_lshl_b32 s22, s16, 12
    s_add_u32 s22, s22, 2367488

    ds_read_b64 v[16:17], v13 offset:3584
    ds_read_b64 v[18:19], v13 offset:3072
    ds_read_b64 v[20:21], v13 offset:2560
    ds_read_b64 v[22:23], v13 offset:2048
    ds_read_b64 v[24:25], v13 offset:1536
    ds_read_b64 v[26:27], v13 offset:1024
    ds_read_b64 v[28:29], v13 offset:512
    ds_read_b64 v[30:31], v13 offset:0
    s_waitcnt lgkmcnt(0)
    v_and_b32 v40, 0xffff0000, v17
    v_lshlrev_b32 v41, 16, v17
    v_and_b32 v42, 0xffff0000, v16
    v_lshlrev_b32 v43, 16, v16
    v_fmac_f32 v144, v40, v14
    v_fmac_f32 v145, v41, v14
    v_fmac_f32 v146, v42, v14
    v_fmac_f32 v147, v43, v14
    v_cvt_pk_bf16_f32 v48, v144, v145
    v_cvt_pk_bf16_f32 v49, v146, v147
    buffer_store_dwordx2 v[48:49], v12, s[8:11], s22 offen offset:0 sc1

    v_and_b32 v40, 0xffff0000, v19
    v_lshlrev_b32 v41, 16, v19
    v_and_b32 v42, 0xffff0000, v18
    v_lshlrev_b32 v43, 16, v18
    v_fmac_f32 v148, v40, v14
    v_fmac_f32 v149, v41, v14
    v_fmac_f32 v150, v42, v14
    v_fmac_f32 v151, v43, v14
    v_cvt_pk_bf16_f32 v50, v148, v149
    v_cvt_pk_bf16_f32 v51, v150, v151
    buffer_store_dwordx2 v[50:51], v12, s[8:11], s22 offen offset:512 sc1

    v_and_b32 v40, 0xffff0000, v21
    v_lshlrev_b32 v41, 16, v21
    v_and_b32 v42, 0xffff0000, v20
    v_lshlrev_b32 v43, 16, v20
    v_fmac_f32 v152, v40, v14
    v_fmac_f32 v153, v41, v14
    v_fmac_f32 v154, v42, v14
    v_fmac_f32 v155, v43, v14
    v_cvt_pk_bf16_f32 v52, v152, v153
    v_cvt_pk_bf16_f32 v53, v154, v155
    buffer_store_dwordx2 v[52:53], v12, s[8:11], s22 offen offset:1024 sc1

    v_and_b32 v40, 0xffff0000, v23
    v_lshlrev_b32 v41, 16, v23
    v_and_b32 v42, 0xffff0000, v22
    v_lshlrev_b32 v43, 16, v22
    v_fmac_f32 v156, v40, v14
    v_fmac_f32 v157, v41, v14
    v_fmac_f32 v158, v42, v14
    v_fmac_f32 v159, v43, v14
    v_cvt_pk_bf16_f32 v54, v156, v157
    v_cvt_pk_bf16_f32 v55, v158, v159
    buffer_store_dwordx2 v[54:55], v12, s[8:11], s22 offen offset:1536 sc1

    v_and_b32 v40, 0xffff0000, v25
    v_lshlrev_b32 v41, 16, v25
    v_and_b32 v42, 0xffff0000, v24
    v_lshlrev_b32 v43, 16, v24
    v_fmac_f32 v160, v40, v14
    v_fmac_f32 v161, v41, v14
    v_fmac_f32 v162, v42, v14
    v_fmac_f32 v163, v43, v14
    v_cvt_pk_bf16_f32 v56, v160, v161
    v_cvt_pk_bf16_f32 v57, v162, v163
    buffer_store_dwordx2 v[56:57], v12, s[8:11], s22 offen offset:2048 sc1

    v_and_b32 v40, 0xffff0000, v27
    v_lshlrev_b32 v41, 16, v27
    v_and_b32 v42, 0xffff0000, v26
    v_lshlrev_b32 v43, 16, v26
    v_fmac_f32 v164, v40, v14
    v_fmac_f32 v165, v41, v14
    v_fmac_f32 v166, v42, v14
    v_fmac_f32 v167, v43, v14
    v_cvt_pk_bf16_f32 v58, v164, v165
    v_cvt_pk_bf16_f32 v59, v166, v167
    buffer_store_dwordx2 v[58:59], v12, s[8:11], s22 offen offset:2560 sc1

    v_and_b32 v40, 0xffff0000, v29
    v_lshlrev_b32 v41, 16, v29
    v_and_b32 v42, 0xffff0000, v28
    v_lshlrev_b32 v43, 16, v28
    v_fmac_f32 v168, v40, v14
    v_fmac_f32 v169, v41, v14
    v_fmac_f32 v170, v42, v14
    v_fmac_f32 v171, v43, v14
    v_cvt_pk_bf16_f32 v60, v168, v169
    v_cvt_pk_bf16_f32 v61, v170, v171
    buffer_store_dwordx2 v[60:61], v12, s[8:11], s22 offen offset:3072 sc1

    v_and_b32 v40, 0xffff0000, v31
    v_lshlrev_b32 v41, 16, v31
    v_and_b32 v42, 0xffff0000, v30
    v_lshlrev_b32 v43, 16, v30
    v_fmac_f32 v172, v40, v14
    v_fmac_f32 v173, v41, v14
    v_fmac_f32 v174, v42, v14
    v_fmac_f32 v175, v43, v14
    v_cvt_pk_bf16_f32 v62, v172, v173
    v_cvt_pk_bf16_f32 v63, v174, v175
    buffer_store_dwordx2 v[62:63], v12, s[8:11], s22 offen offset:3584 sc1

    s_cmp_ge_u32 s98, 4
    s_cbranch_scc1 gated_mix__ssm_conv_h3__dense_activation_gelu__prompt_kernel_no9
    s_add_u32 s16, s23, 8
    s_mov_b32 s17, 0
    s_mov_b32 s20, s24
    s_mov_b32 s21, s25

    s_waitcnt lgkmcnt(0)
    v_mov_b32 v28, 81616
    v_mov_b32 v29, 1
    s_mov_b64 exec, 1
    ds_add_u32 v28, v29
    s_mov_b64 exec, -1
    s_mov_b32 s33, 0
        gated_mix__ssm_conv_h3__dense_activation_gelu__prompt_kernel_n1:
    ds_read_b32 v30, v28
    s_waitcnt lgkmcnt(0)
    v_readfirstlane_b32 s34, v30
    s_add_u32 s33, s33, 1
    s_cmp_ge_u32 s33, 262144
    s_cbranch_scc1 gated_mix__ssm_conv_h3__dense_activation_gelu__prompt_kernel_n1d
    s_cmp_ge_u32 s34, 4
    s_cbranch_scc1 gated_mix__ssm_conv_h3__dense_activation_gelu__prompt_kernel_n1d
    s_sleep 2
    s_branch gated_mix__ssm_conv_h3__dense_activation_gelu__prompt_kernel_n1
        gated_mix__ssm_conv_h3__dense_activation_gelu__prompt_kernel_n1d:

    s_lshr_b32 s33, s17, 2
    s_mul_i32 s33, s33, 81920
    s_and_b32 s34, s17, 3
    s_mul_i32 s26, s34, 8128
    s_add_u32 s26, s26, s33
    s_add_u32 s27, s26, 49088
    s_add_u32 s26, s26, 16448
    s_mul_i32 s28, s34, 4112
    s_add_u32 s28, s28, s33
    s_mov_b32 s29, s27

    v_lshlrev_b32 v10, 4, v1
    s_cmp_lg_u32 s98, 0
    s_cbranch_scc1 gated_mix__ssm_conv_h3__dense_activation_gelu__prompt_kernel_nostg

    v_mov_b32 v24, 0
    v_mov_b32 v25, 0
    v_mov_b32 v26, 0
    v_mov_b32 v27, 0
    v_add_u32 v8, s29, v10
    s_add_u32 s33, s28, 4096
    v_mov_b32 v9, s33
    s_mov_b64 exec, 3
    ds_write_b128 v8, v[24:27]
    s_mov_b64 exec, 1
    ds_write_b128 v9, v[24:27]
    s_mov_b64 exec, 15
    ds_write_b128 v8, v[196:199] offset:32
    s_mov_b64 exec, -1

    v_and_b32 v14, 15, v1
    v_lshrrev_b32 v15, 4, v1
    v_lshl_add_u32 v14, v15, 3, v14
    v_add_u32 v14, 1, v14
    v_lshlrev_b32 v14, 1, v14
    v_add_u32 v14, s29, v14
    s_waitcnt lgkmcnt(0)
    ds_read_b128 v[200:203], v14
    s_waitcnt lgkmcnt(0)

gated_mix__ssm_conv_h3__dense_activation_gelu__prompt_kernel_nostg:
    s_lshl_b32 s34, s98, 10
    s_add_u32 s34, s34, 0
    s_add_u32 s33, s26, s34
    v_add_u32 v9, s33, v10
    s_add_u32 s33, s27, s34
    v_add_u32 v13, s33, v10

    ds_write_b128 v9, v[176:179]
    v_alignbit_b32 v176, v180, v176, 16
    v_alignbit_b32 v177, v181, v177, 16
    v_alignbit_b32 v178, v182, v178, 16
    v_alignbit_b32 v179, v183, v179, 16
    ds_write_b128 v13, v[176:179]
    s_lshl_b32 s34, s98, 10
    s_add_u32 s34, s34, 4096
    s_add_u32 s33, s26, s34
    v_add_u32 v9, s33, v10
    s_add_u32 s33, s27, s34
    v_add_u32 v13, s33, v10

    s_cmp_eq_u32 s98, 3
    s_cselect_b32 exec_hi, 0x0fffffff, -1
    ds_write_b128 v9, v[184:187]
    v_alignbit_b32 v184, v188, v184, 16
    v_alignbit_b32 v185, v189, v185, 16
    v_alignbit_b32 v186, v190, v186, 16
    v_alignbit_b32 v187, v191, v187, 16
    ds_write_b128 v13, v[184:187]
    s_mov_b32 exec_hi, -1
    s_lshl_b32 s34, s98, 10
    s_add_u32 s33, s28, s34
    v_add_u32 v9, s33, v10
    ds_write_b128 v9, v[192:195]

    v_and_b32 v10, 15, v1
    v_lshrrev_b32 v11, 4, v1
    v_add_u32 v12, 1, v10
    v_and_b32 v13, 3, v12
    v_lshrrev_b32 v12, 2, v12
    v_lshl_add_u32 v12, v11, 1, v12
    v_and_b32 v15, 1, v13
    v_mov_b32 v9, s26
    v_mov_b32 v8, s27
    v_cmp_eq_u32 vcc, 1, v15
    s_nop 1
    v_cndmask_b32 v9, v9, v8, vcc
    v_lshrrev_b32 v13, 1, v13
    v_lshl_add_u32 v9, v13, 4, v9
    v_subrev_u32 v9, 128, v9

    s_lshl_b32 s34, s98, 7
    v_add_u32 v9, s34, v9
    v_lshrrev_b32 v14, 1, v12
    v_lshl_add_u32 v14, v14, 5, v9
    v_and_b32 v15, 1, v12
    v_lshl_add_u32 v4, v15, 3, v14
    v_add_u32 v12, 1, v12
    v_lshrrev_b32 v14, 1, v12
    v_lshl_add_u32 v14, v14, 5, v9
    v_and_b32 v15, 1, v12
    v_lshl_add_u32 v5, v15, 3, v14
    v_lshlrev_b32 v14, 5, v10
    v_lshlrev_b32 v15, 4, v11
    v_sub_u32 v14, v15, v14
    s_add_u32 s33, s28, 480

    s_lshl_b32 s34, s98, 6
    s_add_u32 s33, s33, s34
    v_add_u32 v6, s33, v14
    v_add_u32 v8, 3584, v6
    s_add_u32 s33, s28, 4096
    v_mov_b32 v9, s33
    v_min_u32 v7, v8, v9
    v_lshl_add_u32 v14, v11, 3, v10
    v_add_u32 v14, 1, v14
    v_lshlrev_b32 v14, 1, v14
    v_add_u32 v14, s29, v14

    v_mov_b32 v144, 0
    v_mov_b32 v145, 0
    v_mov_b32 v146, 0
    v_mov_b32 v147, 0
    v_mov_b32 v148, 0
    v_mov_b32 v149, 0
    v_mov_b32 v150, 0
    v_mov_b32 v151, 0
    v_mov_b32 v152, 0
    v_mov_b32 v153, 0
    v_mov_b32 v154, 0
    v_mov_b32 v155, 0
    v_mov_b32 v156, 0
    v_mov_b32 v157, 0
    v_mov_b32 v158, 0
    v_mov_b32 v159, 0
    v_mov_b32 v160, 0
    v_mov_b32 v161, 0
    v_mov_b32 v162, 0
    v_mov_b32 v163, 0
    v_mov_b32 v164, 0
    v_mov_b32 v165, 0
    v_mov_b32 v166, 0
    v_mov_b32 v167, 0
    v_mov_b32 v168, 0
    v_mov_b32 v169, 0
    v_mov_b32 v170, 0
    v_mov_b32 v171, 0
    v_mov_b32 v172, 0
    v_mov_b32 v173, 0
    v_mov_b32 v174, 0
    v_mov_b32 v175, 0
    s_waitcnt lgkmcnt(0)
    v_mov_b32 v28, 81620
    v_mov_b32 v29, 1
    s_mov_b64 exec, 1
    ds_add_u32 v28, v29
    s_mov_b64 exec, -1
    s_mov_b32 s33, 0
        gated_mix__ssm_conv_h3__dense_activation_gelu__prompt_kernel_n2:
    ds_read_b32 v30, v28
    s_waitcnt lgkmcnt(0)
    v_readfirstlane_b32 s34, v30
    s_add_u32 s33, s33, 1
    s_cmp_ge_u32 s33, 262144
    s_cbranch_scc1 gated_mix__ssm_conv_h3__dense_activation_gelu__prompt_kernel_n2d
    s_cmp_ge_u32 s34, 4
    s_cbranch_scc1 gated_mix__ssm_conv_h3__dense_activation_gelu__prompt_kernel_n2d
    s_sleep 2
    s_branch gated_mix__ssm_conv_h3__dense_activation_gelu__prompt_kernel_n2
        gated_mix__ssm_conv_h3__dense_activation_gelu__prompt_kernel_n2d:

    ds_read_b64 v[16:17], v4 offset:0
    ds_read_b64 v[18:19], v5 offset:0
    ds_read_b64 v[20:21], v4 offset:1024
    ds_read_b64 v[22:23], v5 offset:1024
    ds_read_b64 v[24:25], v4 offset:2048
    ds_read_b64 v[26:27], v5 offset:2048
    ds_read_b64 v[28:29], v4 offset:3072
    ds_read_b64 v[30:31], v5 offset:3072
    ds_read_b64 v[32:33], v4 offset:4096
    ds_read_b64 v[34:35], v5 offset:4096
    ds_read_b64 v[36:37], v4 offset:5120
    ds_read_b64 v[38:39], v5 offset:5120
    ds_read_b64 v[40:41], v4 offset:6144
    ds_read_b64 v[42:43], v5 offset:6144
    ds_read_b64 v[44:45], v4 offset:7168
    ds_read_b64 v[46:47], v5 offset:7168
    ds_read_b128 v[80:83], v7
    ds_read_b128 v[84:87], v6 offset:3072
    ds_read_b128 v[88:91], v6 offset:2560
    ds_read_b128 v[92:95], v6 offset:2048
    ds_read_b128 v[96:99], v6 offset:1536
    ds_read_b128 v[100:103], v6 offset:1024
    ds_read_b128 v[104:107], v6 offset:512
    ds_read_b128 v[108:111], v6 offset:0
    v_add_u32 v4, 512, v4
    v_add_u32 v5, 512, v5
    v_add_u32 v6, 256, v6
    v_add_u32 v8, 256, v8
    v_min_u32 v7, v8, v9

    s_waitcnt lgkmcnt(0)
    s_cmp_lg_u32 s98, 0
    s_cbranch_scc1 gated_mix__ssm_conv_h3__dense_activation_gelu__prompt_kernel_nospec
    v_mov_b32 v16, v200
    v_mov_b32 v17, v201
    v_mov_b32 v18, v202
    v_mov_b32 v19, v203
    s_nop 1
gated_mix__ssm_conv_h3__dense_activation_gelu__prompt_kernel_nospec:
    ds_read_b64 v[48:49], v4 offset:0
    ds_read_b64 v[50:51], v5 offset:0
    ds_read_b64 v[52:53], v4 offset:1024
    ds_read_b64 v[54:55], v5 offset:1024
    ds_read_b64 v[56:57], v4 offset:2048
    ds_read_b64 v[58:59], v5 offset:2048
    ds_read_b64 v[60:61], v4 offset:3072
    ds_read_b64 v[62:63], v5 offset:3072
    ds_read_b64 v[64:65], v4 offset:4096
    ds_read_b64 v[66:67], v5 offset:4096
    ds_read_b64 v[68:69], v4 offset:5120
    ds_read_b64 v[70:71], v5 offset:5120
    ds_read_b64 v[72:73], v4 offset:6144
    ds_read_b64 v[74:75], v5 offset:6144
    ds_read_b64 v[76:77], v4 offset:7168
    ds_read_b64 v[78:79], v5 offset:7168
    ds_read_b128 v[112:115], v7
    ds_read_b128 v[116:119], v6 offset:3072
    ds_read_b128 v[120:123], v6 offset:2560
    ds_read_b128 v[124:127], v6 offset:2048
    ds_read_b128 v[128:131], v6 offset:1536
    ds_read_b128 v[132:135], v6 offset:1024
    ds_read_b128 v[136:139], v6 offset:512
    ds_read_b128 v[140:143], v6 offset:0
    v_mfma_f32_16x16x32_bf16 v[144:147], v[16:19], v[80:83], v[144:147]
    v_mfma_f32_16x16x32_bf16 v[148:151], v[16:19], v[84:87], v[148:151]
    v_mfma_f32_16x16x32_bf16 v[148:151], v[20:23], v[80:83], v[148:151]
    v_mfma_f32_16x16x32_bf16 v[152:155], v[20:23], v[84:87], v[152:155]
    v_mfma_f32_16x16x32_bf16 v[152:155], v[16:19], v[88:91], v[152:155]
    v_mfma_f32_16x16x32_bf16 v[156:159], v[20:23], v[88:91], v[156:159]
    v_mfma_f32_16x16x32_bf16 v[152:155], v[24:27], v[80:83], v[152:155]
    v_mfma_f32_16x16x32_bf16 v[156:159], v[24:27], v[84:87], v[156:159]
    v_mfma_f32_16x16x32_bf16 v[160:163], v[24:27], v[88:91], v[160:163]
    v_mfma_f32_16x16x32_bf16 v[156:159], v[16:19], v[92:95], v[156:159]
    v_mfma_f32_16x16x32_bf16 v[160:163], v[20:23], v[92:95], v[160:163]
    v_mfma_f32_16x16x32_bf16 v[164:167], v[24:27], v[92:95], v[164:167]
    v_mfma_f32_16x16x32_bf16 v[156:159], v[28:31], v[80:83], v[156:159]
    v_mfma_f32_16x16x32_bf16 v[160:163], v[28:31], v[84:87], v[160:163]
    v_mfma_f32_16x16x32_bf16 v[164:167], v[28:31], v[88:91], v[164:167]
    v_mfma_f32_16x16x32_bf16 v[168:171], v[28:31], v[92:95], v[168:171]
    v_mfma_f32_16x16x32_bf16 v[160:163], v[16:19], v[96:99], v[160:163]
    v_mfma_f32_16x16x32_bf16 v[164:167], v[20:23], v[96:99], v[164:167]
    v_mfma_f32_16x16x32_bf16 v[168:171], v[24:27], v[96:99], v[168:171]
    v_mfma_f32_16x16x32_bf16 v[172:175], v[28:31], v[96:99], v[172:175]
    v_mfma_f32_16x16x32_bf16 v[160:163], v[32:35], v[80:83], v[160:163]
    v_mfma_f32_16x16x32_bf16 v[164:167], v[32:35], v[84:87], v[164:167]
    v_mfma_f32_16x16x32_bf16 v[168:171], v[32:35], v[88:91], v[168:171]
    v_mfma_f32_16x16x32_bf16 v[172:175], v[32:35], v[92:95], v[172:175]
    v_mfma_f32_16x16x32_bf16 v[164:167], v[16:19], v[100:103], v[164:167]
    v_mfma_f32_16x16x32_bf16 v[168:171], v[20:23], v[100:103], v[168:171]
    v_mfma_f32_16x16x32_bf16 v[172:175], v[24:27], v[100:103], v[172:175]
    v_mfma_f32_16x16x32_bf16 v[164:167], v[36:39], v[80:83], v[164:167]
    v_mfma_f32_16x16x32_bf16 v[168:171], v[36:39], v[84:87], v[168:171]
    v_mfma_f32_16x16x32_bf16 v[172:175], v[36:39], v[88:91], v[172:175]
    v_mfma_f32_16x16x32_bf16 v[168:171], v[16:19], v[104:107], v[168:171]
    v_mfma_f32_16x16x32_bf16 v[172:175], v[20:23], v[104:107], v[172:175]
    v_mfma_f32_16x16x32_bf16 v[168:171], v[40:43], v[80:83], v[168:171]
    v_mfma_f32_16x16x32_bf16 v[172:175], v[40:43], v[84:87], v[172:175]
    v_mfma_f32_16x16x32_bf16 v[172:175], v[16:19], v[108:111], v[172:175]
    v_mfma_f32_16x16x32_bf16 v[172:175], v[44:47], v[80:83], v[172:175]
    s_waitcnt lgkmcnt(0)
    v_mfma_f32_16x16x32_bf16 v[144:147], v[48:51], v[112:115], v[144:147]
    v_mfma_f32_16x16x32_bf16 v[148:151], v[48:51], v[116:119], v[148:151]
    v_mfma_f32_16x16x32_bf16 v[148:151], v[52:55], v[112:115], v[148:151]
    v_mfma_f32_16x16x32_bf16 v[152:155], v[52:55], v[116:119], v[152:155]
    v_mfma_f32_16x16x32_bf16 v[152:155], v[48:51], v[120:123], v[152:155]
    v_mfma_f32_16x16x32_bf16 v[156:159], v[52:55], v[120:123], v[156:159]
    v_mfma_f32_16x16x32_bf16 v[152:155], v[56:59], v[112:115], v[152:155]
    v_mfma_f32_16x16x32_bf16 v[156:159], v[56:59], v[116:119], v[156:159]
    v_mfma_f32_16x16x32_bf16 v[160:163], v[56:59], v[120:123], v[160:163]
    v_mfma_f32_16x16x32_bf16 v[156:159], v[48:51], v[124:127], v[156:159]
    v_mfma_f32_16x16x32_bf16 v[160:163], v[52:55], v[124:127], v[160:163]
    v_mfma_f32_16x16x32_bf16 v[164:167], v[56:59], v[124:127], v[164:167]
    v_mfma_f32_16x16x32_bf16 v[156:159], v[60:63], v[112:115], v[156:159]
    v_mfma_f32_16x16x32_bf16 v[160:163], v[60:63], v[116:119], v[160:163]
    v_mfma_f32_16x16x32_bf16 v[164:167], v[60:63], v[120:123], v[164:167]
    v_mfma_f32_16x16x32_bf16 v[168:171], v[60:63], v[124:127], v[168:171]
    v_mfma_f32_16x16x32_bf16 v[160:163], v[48:51], v[128:131], v[160:163]
    v_mfma_f32_16x16x32_bf16 v[164:167], v[52:55], v[128:131], v[164:167]
    v_mfma_f32_16x16x32_bf16 v[168:171], v[56:59], v[128:131], v[168:171]
    v_mfma_f32_16x16x32_bf16 v[172:175], v[60:63], v[128:131], v[172:175]
    v_mfma_f32_16x16x32_bf16 v[160:163], v[64:67], v[112:115], v[160:163]
    v_mfma_f32_16x16x32_bf16 v[164:167], v[64:67], v[116:119], v[164:167]
    v_mfma_f32_16x16x32_bf16 v[168:171], v[64:67], v[120:123], v[168:171]
    v_mfma_f32_16x16x32_bf16 v[172:175], v[64:67], v[124:127], v[172:175]
    v_mfma_f32_16x16x32_bf16 v[164:167], v[48:51], v[132:135], v[164:167]
    v_mfma_f32_16x16x32_bf16 v[168:171], v[52:55], v[132:135], v[168:171]
    v_mfma_f32_16x16x32_bf16 v[172:175], v[56:59], v[132:135], v[172:175]
    v_mfma_f32_16x16x32_bf16 v[164:167], v[68:71], v[112:115], v[164:167]
    v_mfma_f32_16x16x32_bf16 v[168:171], v[68:71], v[116:119], v[168:171]
    v_mfma_f32_16x16x32_bf16 v[172:175], v[68:71], v[120:123], v[172:175]
    v_mfma_f32_16x16x32_bf16 v[168:171], v[48:51], v[136:139], v[168:171]
    v_mfma_f32_16x16x32_bf16 v[172:175], v[52:55], v[136:139], v[172:175]
    v_mfma_f32_16x16x32_bf16 v[168:171], v[72:75], v[112:115], v[168:171]
    v_mfma_f32_16x16x32_bf16 v[172:175], v[72:75], v[116:119], v[172:175]
    v_mfma_f32_16x16x32_bf16 v[172:175], v[48:51], v[140:143], v[172:175]
    v_mfma_f32_16x16x32_bf16 v[172:175], v[76:79], v[112:115], v[172:175]
    v_lshlrev_b32 v10, 4, v1
    s_lshl_b32 s33, s98, 13
    s_add_u32 s34, s33, 24576
    s_add_u32 s33, s33, 40832
    s_cmp_ge_u32 s98, 2
    s_cselect_b32 s33, s33, s34
    v_add_u32 v11, s33, v10
    s_nop 7

    ds_write_b128 v11, v[144:147] offset:0
    ds_write_b128 v11, v[148:151] offset:1024
    ds_write_b128 v11, v[152:155] offset:2048
    ds_write_b128 v11, v[156:159] offset:3072
    ds_write_b128 v11, v[160:163] offset:4096
    ds_write_b128 v11, v[164:167] offset:5120
    ds_write_b128 v11, v[168:171] offset:6144
    ds_write_b128 v11, v[172:175] offset:7168
    s_waitcnt lgkmcnt(0)
    v_mov_b32 v28, 81624
    v_mov_b32 v29, 1
    s_mov_b64 exec, 1
    ds_add_u32 v28, v29
    s_mov_b64 exec, -1
    s_mov_b32 s33, 0
        gated_mix__ssm_conv_h3__dense_activation_gelu__prompt_kernel_n3:
    ds_read_b32 v30, v28
    s_waitcnt lgkmcnt(0)
    v_readfirstlane_b32 s34, v30
    s_add_u32 s33, s33, 1
    s_cmp_ge_u32 s33, 262144
    s_cbranch_scc1 gated_mix__ssm_conv_h3__dense_activation_gelu__prompt_kernel_n3d
    s_cmp_ge_u32 s34, 4
    s_cbranch_scc1 gated_mix__ssm_conv_h3__dense_activation_gelu__prompt_kernel_n3d
    s_sleep 2
    s_branch gated_mix__ssm_conv_h3__dense_activation_gelu__prompt_kernel_n3
        gated_mix__ssm_conv_h3__dense_activation_gelu__prompt_kernel_n3d:

    s_and_b32 s33, s20, 2
    s_lshl_b32 s33, s33, 3
    s_lshr_b32 s21, s21, s33
    s_lshl_b32 s21, s21, 16

    s_lshl_b32 s35, s98, 10
    s_add_u32 s35, s35, 0
    s_add_u32 s34, s35, 24576
    v_add_u32 v11, s34, v10
    s_add_u32 s34, s35, 57216
    v_add_u32 v9, s34, v10
    ds_read_b128 v[48:51], v11
    ds_read_b128 v[52:55], v11 offset:8192
    ds_read_b128 v[56:59], v9
    ds_read_b128 v[60:63], v9 offset:8192
    v_and_b32 v12, 15, v1
    v_lshrrev_b32 v13, 4, v1
    v_lshlrev_b32 v12, 5, v12
    v_lshl_add_u32 v12, v13, 3, v12
    s_lshr_b32 s35, s35, 1
    s_add_u32 s33, s28, 4088
    s_sub_u32 s33, s33, s35
    v_sub_u32 v13, s33, v12
    ds_read_b64 v[16:17], v13
    v_mov_b32 v14, s21
    s_lshl_b32 s22, s16, 12
    s_add_u32 s22, s22, 2367488
    s_add_u32 s22, s22, s35
    s_waitcnt lgkmcnt(0)

    v_add_f32 v48, v48, v52
    v_add_f32 v56, v56, v60
    v_add_f32 v48, v48, v56
    v_add_f32 v49, v49, v53
    v_add_f32 v57, v57, v61
    v_add_f32 v49, v49, v57
    v_add_f32 v50, v50, v54
    v_add_f32 v58, v58, v62
    v_add_f32 v50, v50, v58
    v_add_f32 v51, v51, v55
    v_add_f32 v59, v59, v63
    v_add_f32 v51, v51, v59
    v_and_b32 v40, 0xffff0000, v17
    v_lshlrev_b32 v41, 16, v17
    v_and_b32 v42, 0xffff0000, v16
    v_lshlrev_b32 v43, 16, v16
    v_fmac_f32 v48, v40, v14
    v_fmac_f32 v49, v41, v14
    v_fmac_f32 v50, v42, v14
    v_fmac_f32 v51, v43, v14
    v_cvt_pk_bf16_f32 v80, v48, v49
    v_cvt_pk_bf16_f32 v81, v50, v51
    buffer_store_dwordx2 v[80:81], v12, s[8:11], s22 offen sc1

    s_lshl_b32 s35, s98, 10
    s_add_u32 s35, s35, 4096
    s_add_u32 s34, s35, 24576
    v_add_u32 v11, s34, v10
    s_add_u32 s34, s35, 57216
    v_add_u32 v9, s34, v10
    ds_read_b128 v[48:51], v11
    ds_read_b128 v[52:55], v11 offset:8192
    ds_read_b128 v[56:59], v9
    ds_read_b128 v[60:63], v9 offset:8192
    v_and_b32 v12, 15, v1
    v_lshrrev_b32 v13, 4, v1
    v_lshlrev_b32 v12, 5, v12
    v_lshl_add_u32 v12, v13, 3, v12
    s_lshr_b32 s35, s35, 1
    s_add_u32 s33, s28, 4088
    s_sub_u32 s33, s33, s35
    v_sub_u32 v13, s33, v12
    ds_read_b64 v[16:17], v13
    v_mov_b32 v14, s21
    s_lshl_b32 s22, s16, 12
    s_add_u32 s22, s22, 2367488
    s_add_u32 s22, s22, s35
    s_waitcnt lgkmcnt(0)

    v_add_f32 v48, v48, v52
    v_add_f32 v56, v56, v60
    v_add_f32 v48, v48, v56
    v_add_f32 v49, v49, v53
    v_add_f32 v57, v57, v61
    v_add_f32 v49, v49, v57
    v_add_f32 v50, v50, v54
    v_add_f32 v58, v58, v62
    v_add_f32 v50, v50, v58
    v_add_f32 v51, v51, v55
    v_add_f32 v59, v59, v63
    v_add_f32 v51, v51, v59
    v_and_b32 v40, 0xffff0000, v17
    v_lshlrev_b32 v41, 16, v17
    v_and_b32 v42, 0xffff0000, v16
    v_lshlrev_b32 v43, 16, v16
    v_fmac_f32 v48, v40, v14
    v_fmac_f32 v49, v41, v14
    v_fmac_f32 v50, v42, v14
    v_fmac_f32 v51, v43, v14
    v_cvt_pk_bf16_f32 v82, v48, v49
    v_cvt_pk_bf16_f32 v83, v50, v51
    buffer_store_dwordx2 v[82:83], v12, s[8:11], s22 offen sc1

gated_mix__ssm_conv_h3__dense_activation_gelu__prompt_kernel_no9:
    s_waitcnt vmcnt(0)
    s_barrier
    s_cmp_lg_u32 s98, 0
    s_cbranch_scc1 gated_mix__ssm_conv_h3__dense_activation_gelu__prompt_kernel_cvdone

    s_add_u32 s24, s99, 144
    s_or_b32 s33, s96, 2
    v_mov_b32 v24, s33
    v_mov_b32 v25, s97
    s_lshl_b32 s33, s24, 6
    v_mov_b32 v26, s33
    s_mov_b64 s[30:31], exec
    s_mov_b64 exec, 1
    buffer_store_dwordx2 v[24:25], v26, s[92:95], 0 offen sc1
    s_mov_b64 exec, s[30:31]

    s_waitcnt vmcnt(0)
gated_mix__ssm_conv_h3__dense_activation_gelu__prompt_kernel_cvdone:
gated_mix__ssm_conv_h3__dense_activation_gelu__prompt_kernel_fin:
gated_mix__ssm_conv_h3__dense_activation_gelu__prompt_kernel_end:
    s_endpgm
.section .rodata,"a"
.p2align 6
.amdhsa_kernel gated_mix__ssm_conv_h3__dense_activation_gelu__prompt_kernel
    .amdhsa_next_free_vgpr 256
    .amdhsa_next_free_sgpr 102
    .amdhsa_accum_offset 256
    .amdhsa_group_segment_fixed_size 0
    .amdhsa_kernarg_size 120
    .amdhsa_user_sgpr_count 2
    .amdhsa_user_sgpr_kernarg_segment_ptr 1
    .amdhsa_system_sgpr_workgroup_id_x 1
.end_amdhsa_kernel
.text
```
